```python
import torch

def _softmax(x, axis=-1):
    return torch.softmax(x, dim=axis)
def _gelu(x):
    return torch.nn.functional.gelu(x, approximate="tanh")
def _silu(x):
    return torch.nn.functional.silu(x)
def _sigmoid(x):
    return torch.sigmoid(x)
def _layernorm(x, axis=-1, eps=1e-5):
    m = x.mean(dim=axis, keepdim=True)
    v = x.var(dim=axis, keepdim=True, unbiased=False)
    return (x - m) / torch.sqrt(v + eps)
def _scatter_add(tgt, idx, src, axis=0):
    return tgt.clone().index_add_(axis, idx, src)
def _segment_sum(src, seg, n):
    out = torch.zeros((n,) + src.shape[1:], dtype=src.dtype)
    return out.index_add_(0, seg, src)
def _pad(x, pw):
    flat = tuple(v for pair in reversed(pw) for v in pair)
    return torch.nn.functional.pad(x, flat)

kernel_name = 'interleave_layers__mha_block__mixer_token_mlp__prompt'

def setup_inputs():

    _w = (lambda a: (lambda t: t.to(torch.bfloat16) if t.is_floating_point() else t)(torch.as_tensor(a)))
    def _A_setup():
        B, S, D, H = 1, 2048, 640, 32
        return {
            "x": _w((lambda *s: torch.randn(*s, dtype=torch.bfloat16) * 0.05)(B, S, D)),
            "wqkv": _w((lambda *s: torch.randn(*s, dtype=torch.bfloat16) * 0.05)(D, 3 * D)),
            "wo": _w((lambda *s: torch.randn(*s, dtype=torch.bfloat16) * 0.05)(D, D)),
        }
    _A_in = _A_setup()

    def _B_setup():
        B, S, D, F = 1, 2048, 640, 1536
        return {
            "x": _w((lambda *s: torch.randn(*s, dtype=torch.bfloat16) * 0.05)(B, S, D)),
            "w1": _w((lambda *s: torch.randn(*s, dtype=torch.bfloat16) * 0.8)(S, F) * (S ** -0.5)),
            "b1": _w((lambda *s: torch.randn(*s, dtype=torch.bfloat16) * 12.8)(F) * 0.02),
            "w2": _w((lambda *s: torch.randn(*s, dtype=torch.bfloat16) * 0.4)(F, S) * (F ** -0.5)),
            "b2": _w((lambda *s: torch.randn(*s, dtype=torch.bfloat16) * 6.4)(S) * 0.02),
        }
    _B_in = _B_setup()

    return {
        "A_x": _A_in["x"],
        "A_wqkv": _A_in["wqkv"],
        "A_wo": _A_in["wo"],
        "B_x": _B_in["x"],
        "B_w1": _B_in["w1"],
        "B_b1": _B_in["b1"],
        "B_w2": _B_in["w2"],
        "B_b2": _B_in["b2"],
    }

def reference(A_x, A_wqkv, A_wo, B_x, B_w1, B_b1, B_w2, B_b2):
    def _A_ref(x, wqkv, wo):
        B, S, D = x.shape
        H = 32
        Dh = D // H
        qkv = (lambda x, *d: x.permute(*d))((x @ wqkv).reshape(B, S, 3, H, Dh), 2, 0, 3, 1, 4)
        q, k, v = qkv[0], qkv[1], qkv[2]
        scores = torch.einsum("bhqd,bhkd->bhqk", q, k) * (Dh ** -0.5)
        p = _softmax(scores, axis=-1)
        o = torch.einsum("bhqk,bhkd->bhqd", p, v)
        return (lambda x, *d: x.permute(*d))(o, 0, 2, 1, 3).reshape(B, S, D) @ wo

    def _B_ref(x, w1, b1, w2, b2):
        B, S, D = x.shape
        h = _layernorm(x, axis=-1)
        u = torch.einsum("bsd,sf->bdf", h, w1) + b1
        u = _gelu(u)
        y = torch.einsum("bdf,fs->bds", u, w2) + b2
        return (lambda x, *d: x.permute(*d))(y, 0, 2, 1)

    x = A_x
    x = x + _A_ref(_layernorm(x, axis=-1), A_wqkv, A_wo)
    x = x + _B_ref(_layernorm(x, axis=-1), B_w1, B_b1, B_w2, B_b2)
    x = x + _A_ref(_layernorm(x, axis=-1), A_wqkv, A_wo)
    x = x + _B_ref(_layernorm(x, axis=-1), B_w1, B_b1, B_w2, B_b2)
    return x
```

```asm
; @launch grid=(256,1,1) block=(256,1,1) lds=163840
.amdgcn_target "amdgcn-amd-amdhsa--gfx950"
.text
.globl interleave_layers__mha_block__mixer_token_mlp__prompt_kernel
.p2align 8
.type interleave_layers__mha_block__mixer_token_mlp__prompt_kernel,@function
interleave_layers__mha_block__mixer_token_mlp__prompt_kernel:
    s_cmp_ge_u32 s2, 256
    s_cbranch_scc1 L_exit
    s_load_dwordx16 s[64:79], s[0:1], 0
    s_load_dwordx4 s[84:87], s[0:1], 64
    s_load_dwordx2 s[88:89], s[0:1], 80
    v_lshrrev_b32 v1, 6, v0
    v_and_b32 v0, 63, v0
    s_nop 0
    v_readfirstlane_b32 s52, v1
    s_and_b32 s61, s2, 7
    s_lshr_b32 s62, s2, 3
    s_lshr_b32 s63, s61, 1
    s_and_b32 s61, s61, 1
    s_lshl_b32 s54, s63, 1
    s_lshr_b32 s3, s62, 4
    s_add_u32 s54, s54, s3
    s_lshl_b32 s55, s61, 4
    s_and_b32 s3, s62, 15
    s_add_u32 s55, s55, s3
    s_lshl_b32 s56, s63, 3
    s_lshr_b32 s3, s62, 2
    s_add_u32 s56, s56, s3
    s_lshl_b32 s57, s61, 2
    s_and_b32 s3, s62, 3
    s_add_u32 s57, s57, s3
    s_mul_i32 s3, s62, 13
    s_lshr_b32 s3, s3, 6
    s_mul_i32 s59, s63, 6
    s_add_u32 s59, s59, s3
    s_mul_i32 s3, s3, 5
    s_sub_u32 s3, s62, s3
    s_mul_i32 s58, s61, 5
    s_add_u32 s58, s58, s3
    s_cmp_lt_u32 s62, 30
    s_cselect_b32 s60, 1, 0
    s_mov_b32 s53, 0
    s_lshr_b32 s100, s2, 3
    s_and_b32 s100, s100, 7
    s_waitcnt lgkmcnt(0)
    s_mov_b32 s4, s64
    s_mov_b32 s5, s65
    s_mov_b32 s6, 2621440
    s_mov_b32 s7, 0x20000
    s_mov_b32 s8, s66
    s_mov_b32 s9, s67
    s_mov_b32 s10, 2457600
    s_mov_b32 s11, 0x20000
    s_mov_b32 s12, s68
    s_mov_b32 s13, s69
    s_mov_b32 s14, 819200
    s_mov_b32 s15, 0x20000
    s_mov_b32 s16, s72
    s_mov_b32 s17, s73
    s_mov_b32 s18, 6291456
    s_mov_b32 s19, 0x20000
    s_mov_b32 s24, s74
    s_mov_b32 s25, s75
    s_mov_b32 s26, 3072
    s_mov_b32 s27, 0x20000
    s_mov_b32 s20, s76
    s_mov_b32 s21, s77
    s_mov_b32 s22, 6291456
    s_mov_b32 s23, 0x20000
    s_mov_b32 s28, s78
    s_mov_b32 s29, s79
    s_mov_b32 s30, 4096
    s_mov_b32 s31, 0x20000
    s_mov_b32 s32, s84
    s_mov_b32 s33, s85
    s_mov_b32 s34, 2621440
    s_mov_b32 s35, 0x20000
    s_mov_b32 s36, s86
    s_mov_b32 s37, s87
    s_mov_b32 s38, 256
    s_mov_b32 s39, 0x20000
    s_mov_b32 s40, s88
    s_mov_b32 s41, s89
    s_mov_b32 s42, 36765696
    s_mov_b32 s43, 0x20000
    s_mov_b32 s48, s88
    s_mov_b32 s49, s89
    s_mov_b32 s50, 36765696
    s_mov_b32 s51, 0x20000
    buffer_load_dword v243, off, s[40:43], 0 sc1
    s_lshl_b32 s61, s56, 2
    s_add_u32 s61, s61, s52
    s_mul_i32 s61, s61, 20480
    s_mul_i32 s62, s57, 160
    s_add_u32 s61, s61, s62
    v_and_b32 v2, 15, v0
    v_mul_u32_u24 v2, 1280, v2
    v_lshrrev_b32 v3, 4, v0
    v_lshl_add_u32 v2, v3, 3, v2
    buffer_load_dwordx2 v[246:247], v2, s[4:7], s61 offen offset:0
    buffer_load_dwordx2 v[248:249], v2, s[4:7], s61 offen offset:32
    buffer_load_dwordx2 v[250:251], v2, s[4:7], s61 offen offset:64
    buffer_load_dwordx2 v[252:253], v2, s[4:7], s61 offen offset:96
    buffer_load_dwordx2 v[254:255], v2, s[4:7], s61 offen offset:128
    s_lshr_b32 s67, s2, 3
    s_mul_i32 s67, s67, 3
    s_mul_i32 s61, s67, 205
    s_lshr_b32 s61, s61, 11
    s_mul_i32 s61, s61, 10
    s_sub_u32 s67, s67, s61
    s_lshr_b32 s61, s2, 3
    s_lshl_b32 s61, s61, 2
    s_add_u32 s61, s61, s52
    s_mul_i32 s61, s61, 75
    s_and_b32 s62, s2, 1
    s_mul_i32 s62, s62, 640
    v_add_u32 v233, 0, v0
    v_mul_u32_u24 v224, 7282, v233
    v_lshrrev_b32 v224, 16, v224
    v_mul_u32_u24 v234, 9, v224
    v_sub_u32 v233, v233, v234
    v_mul_u32_u24 v234, 22, v233
    v_lshrrev_b32 v234, 6, v234
    v_mul_u32_u24 v224, 3840, v224
    v_lshlrev_b32 v233, 4, v233
    v_add_u32 v224, v224, v233
    v_mul_u32_u24 v234, 1232, v234
    v_add_u32 v224, v224, v234
    v_add_u32 v233, 64, v0
    v_mul_u32_u24 v225, 7282, v233
    v_lshrrev_b32 v225, 16, v225
    v_mul_u32_u24 v234, 9, v225
    v_sub_u32 v233, v233, v234
    v_mul_u32_u24 v234, 22, v233
    v_lshrrev_b32 v234, 6, v234
    v_mul_u32_u24 v225, 3840, v225
    v_lshlrev_b32 v233, 4, v233
    v_add_u32 v225, v225, v233
    v_mul_u32_u24 v234, 1232, v234
    v_add_u32 v225, v225, v234
    v_add_u32 v233, 128, v0
    v_mul_u32_u24 v226, 7282, v233
    v_lshrrev_b32 v226, 16, v226
    v_mul_u32_u24 v234, 9, v226
    v_sub_u32 v233, v233, v234
    v_mul_u32_u24 v234, 22, v233
    v_lshrrev_b32 v234, 6, v234
    v_mul_u32_u24 v226, 3840, v226
    v_lshlrev_b32 v233, 4, v233
    v_add_u32 v226, v226, v233
    v_mul_u32_u24 v234, 1232, v234
    v_add_u32 v226, v226, v234
    v_add_u32 v233, 192, v0
    v_mul_u32_u24 v227, 7282, v233
    v_lshrrev_b32 v227, 16, v227
    v_mul_u32_u24 v234, 9, v227
    v_sub_u32 v233, v233, v234
    v_mul_u32_u24 v234, 22, v233
    v_lshrrev_b32 v234, 6, v234
    v_mul_u32_u24 v227, 3840, v227
    v_lshlrev_b32 v233, 4, v233
    v_add_u32 v227, v227, v233
    v_mul_u32_u24 v234, 1232, v234
    v_add_u32 v227, v227, v234
    v_add_u32 v233, 256, v0
    v_mul_u32_u24 v228, 7282, v233
    v_lshrrev_b32 v228, 16, v228
    v_mul_u32_u24 v234, 9, v228
    v_sub_u32 v233, v233, v234
    v_mul_u32_u24 v234, 22, v233
    v_lshrrev_b32 v234, 6, v234
    v_mul_u32_u24 v228, 3840, v228
    v_lshlrev_b32 v233, 4, v233
    v_add_u32 v228, v228, v233
    v_mul_u32_u24 v234, 1232, v234
    v_add_u32 v228, v228, v234
    v_add_u32 v233, 320, v0
    v_mul_u32_u24 v229, 7282, v233
    v_lshrrev_b32 v229, 16, v229
    v_mul_u32_u24 v234, 9, v229
    v_sub_u32 v233, v233, v234
    v_mul_u32_u24 v234, 22, v233
    v_lshrrev_b32 v234, 6, v234
    v_mul_u32_u24 v229, 3840, v229
    v_lshlrev_b32 v233, 4, v233
    v_add_u32 v229, v229, v233
    v_mul_u32_u24 v234, 1232, v234
    v_add_u32 v229, v229, v234
    v_add_u32 v233, 384, v0
    v_mul_u32_u24 v230, 7282, v233
    v_lshrrev_b32 v230, 16, v230
    v_mul_u32_u24 v234, 9, v230
    v_sub_u32 v233, v233, v234
    v_mul_u32_u24 v234, 22, v233
    v_lshrrev_b32 v234, 6, v234
    v_mul_u32_u24 v230, 3840, v230
    v_lshlrev_b32 v233, 4, v233
    v_add_u32 v230, v230, v233
    v_mul_u32_u24 v234, 1232, v234
    v_add_u32 v230, v230, v234
    v_add_u32 v233, 448, v0
    v_mul_u32_u24 v231, 7282, v233
    v_lshrrev_b32 v231, 16, v231
    v_mul_u32_u24 v234, 9, v231
    v_sub_u32 v233, v233, v234
    v_mul_u32_u24 v234, 22, v233
    v_lshrrev_b32 v234, 6, v234
    v_mul_u32_u24 v231, 3840, v231
    v_lshlrev_b32 v233, 4, v233
    v_add_u32 v231, v231, v233
    v_mul_u32_u24 v234, 1232, v234
    v_add_u32 v231, v231, v234
    v_add_u32 v233, 512, v0
    v_mul_u32_u24 v232, 7282, v233
    v_lshrrev_b32 v232, 16, v232
    v_mul_u32_u24 v234, 9, v232
    v_sub_u32 v233, v233, v234
    v_mul_u32_u24 v234, 22, v233
    v_lshrrev_b32 v234, 6, v234
    v_mul_u32_u24 v232, 3840, v232
    v_lshlrev_b32 v233, 4, v233
    v_add_u32 v232, v232, v233
    v_mul_u32_u24 v234, 1232, v234
    v_add_u32 v232, v232, v234
    s_add_u32 s61, s52, s67
    s_add_u32 s61, s61, 0
    s_sub_u32 s62, s61, 10
    s_cmp_ge_u32 s61, 10
    s_cselect_b32 s61, s62, s61
    s_mul_i32 s62, s61, 245760
    s_mul_i32 s63, s55, 40
    s_add_u32 s62, s62, s63
    s_mul_i32 s63, s61, 9216
    s_add_u32 m0, s63, 0
    s_nop 0
    buffer_load_dwordx4 v224, s[8:11], s62 offen lds
    s_add_u32 m0, s63, 1024
    s_nop 0
    buffer_load_dwordx4 v225, s[8:11], s62 offen lds
    s_add_u32 m0, s63, 2048
    s_nop 0
    buffer_load_dwordx4 v226, s[8:11], s62 offen lds
    s_add_u32 m0, s63, 3072
    s_nop 0
    buffer_load_dwordx4 v227, s[8:11], s62 offen lds
    s_add_u32 m0, s63, 4096
    s_nop 0
    buffer_load_dwordx4 v228, s[8:11], s62 offen lds
    s_add_u32 m0, s63, 5120
    s_nop 0
    buffer_load_dwordx4 v229, s[8:11], s62 offen lds
    s_add_u32 m0, s63, 6144
    s_nop 0
    buffer_load_dwordx4 v230, s[8:11], s62 offen lds
    s_add_u32 m0, s63, 7168
    s_nop 0
    buffer_load_dwordx4 v231, s[8:11], s62 offen lds
    s_add_u32 m0, s63, 8192
    s_nop 0
    buffer_load_dwordx4 v232, s[8:11], s62 offen lds
    v_and_b32 v5, 15, v0
    v_bfe_u32 v6, v0, 4, 1
    v_lshrrev_b32 v7, 5, v0
    s_lshl_b32 s61, s56, 1
    s_lshr_b32 s62, s52, 1
    s_add_u32 s61, s61, s62
    s_mul_i32 s61, s61, 40
    s_mul_i32 s62, s57, 5
    s_add_u32 s61, s61, s62
    s_lshl_b32 s61, s61, 10
    s_and_b32 s62, s52, 1
    s_lshl_b32 s62, s62, 8
    s_add_u32 s61, s61, s62
    s_add_u32 s61, s61, 28311552
    v_lshlrev_b32 v5, 4, v5
    v_lshl_add_u32 v5, v7, 9, v5
    v_lshl_add_u32 v2, v6, 10, v5
    v_add_u32 v3, 2048, v2
    v_lshl_add_u32 v4, v6, 3, v5
    v_add_u32 v4, 4096, v4
    s_waitcnt vmcnt(9)
    v_readfirstlane_b32 s99, v243
    s_mul_i32 s99, s99, 1664525
    s_add_u32 s99, s99, 1013904223
    v_mov_b32 v243, s99
    v_mov_b32 v48, v246
    v_mov_b32 v49, v247
    v_mov_b32 v50, v248
    v_mov_b32 v51, v249
    v_mov_b32 v52, v250
    v_mov_b32 v53, v251
    v_mov_b32 v54, v252
    v_mov_b32 v55, v253
    buffer_store_dwordx2 v[254:255], v4, s[40:43], s61 offen sc1
    v_permlane16_swap_b32 v48, v50
    v_permlane16_swap_b32 v49, v51
    v_permlane16_swap_b32 v52, v54
    v_permlane16_swap_b32 v53, v55
    buffer_store_dwordx4 v[48:51], v2, s[40:43], s61 offen sc1
    buffer_store_dwordx4 v[52:55], v3, s[40:43], s61 offen sc1
    s_mov_b32 s61, 0xffff0000
    v_lshlrev_b32 v16, 16, v246
    v_and_b32 v17, s61, v246
    v_lshlrev_b32 v18, 16, v247
    v_and_b32 v19, s61, v247
    v_lshlrev_b32 v20, 16, v248
    v_and_b32 v21, s61, v248
    v_lshlrev_b32 v22, 16, v249
    v_and_b32 v23, s61, v249
    v_lshlrev_b32 v24, 16, v250
    v_and_b32 v25, s61, v250
    v_lshlrev_b32 v26, 16, v251
    v_and_b32 v27, s61, v251
    v_lshlrev_b32 v28, 16, v252
    v_and_b32 v29, s61, v252
    v_lshlrev_b32 v30, 16, v253
    v_and_b32 v31, s61, v253
    v_lshlrev_b32 v32, 16, v254
    v_and_b32 v33, s61, v254
    v_lshlrev_b32 v34, 16, v255
    v_and_b32 v35, s61, v255
    v_add_f32 v40, v16, v17
    v_mul_f32 v41, v16, v16
    v_fmac_f32 v41, v17, v17
    v_add_f32 v40, v40, v18
    v_fmac_f32 v41, v18, v18
    v_add_f32 v40, v40, v19
    v_fmac_f32 v41, v19, v19
    v_add_f32 v40, v40, v20
    v_fmac_f32 v41, v20, v20
    v_add_f32 v40, v40, v21
    v_fmac_f32 v41, v21, v21
    v_add_f32 v40, v40, v22
    v_fmac_f32 v41, v22, v22
    v_add_f32 v40, v40, v23
    v_fmac_f32 v41, v23, v23
    v_add_f32 v40, v40, v24
    v_fmac_f32 v41, v24, v24
    v_add_f32 v40, v40, v25
    v_fmac_f32 v41, v25, v25
    v_add_f32 v40, v40, v26
    v_fmac_f32 v41, v26, v26
    v_add_f32 v40, v40, v27
    v_fmac_f32 v41, v27, v27
    v_add_f32 v40, v40, v28
    v_fmac_f32 v41, v28, v28
    v_add_f32 v40, v40, v29
    v_fmac_f32 v41, v29, v29
    v_add_f32 v40, v40, v30
    v_fmac_f32 v41, v30, v30
    v_add_f32 v40, v40, v31
    v_fmac_f32 v41, v31, v31
    v_add_f32 v40, v40, v32
    v_fmac_f32 v41, v32, v32
    v_add_f32 v40, v40, v33
    v_fmac_f32 v41, v33, v33
    v_add_f32 v40, v40, v34
    v_fmac_f32 v41, v34, v34
    v_add_f32 v40, v40, v35
    v_fmac_f32 v41, v35, v35
    v_mov_b32 v42, v40
    s_nop 1
    v_permlane16_swap_b32 v40, v42
    v_add_f32 v40, v40, v42
    v_mov_b32 v42, v40
    s_nop 1
    v_permlane32_swap_b32 v40, v42
    v_add_f32 v40, v40, v42
    v_mov_b32 v42, v41
    s_nop 1
    v_permlane16_swap_b32 v41, v42
    v_add_f32 v41, v41, v42
    v_mov_b32 v42, v41
    s_nop 1
    v_permlane32_swap_b32 v41, v42
    v_add_f32 v41, v41, v42
    s_lshl_b32 s62, s56, 2
    s_add_u32 s62, s62, s52
    s_lshl_b32 s62, s62, 10
    v_and_b32 v43, 15, v0
    v_lshlrev_b32 v43, 6, v43
    v_add_u32 v43, s62, v43
    s_lshl_b32 s61, s57, 3
    s_add_u32 s62, s61, 65536
    s_add_u32 s63, s61, 327680
    s_add_u32 s64, s61, 458752
    v_mov_b32 v44, -1
    v_mov_b32 v45, -1
    s_mov_b64 exec, 0xffff
    buffer_store_dwordx2 v[40:41], v43, s[40:43], s62 offen sc1
    buffer_store_dwordx2 v[44:45], v43, s[40:43], s63 offen sc1
    buffer_store_dwordx2 v[44:45], v43, s[40:43], s64 offen sc1
    s_mov_b64 exec, -1
    v_and_b32 v240, 31, v0
    v_lshlrev_b32 v240, 2, v240
    s_lshl_b32 s69, s53, 16
    s_add_u32 s69, s69, 36634624
    s_lshl_b32 s68, s54, 7
    s_add_u32 s69, s69, s68
    s_lshl_b32 s68, s100, 10
    s_add_u32 s69, s69, s68
    s_lshl_b32 s101, s53, 16
    s_add_u32 s101, s101, 36634624
    s_lshl_b32 s68, s56, 5
    s_add_u32 s101, s101, s68
    s_lshl_b32 s68, s57, 2
    s_add_u32 s101, s101, s68
    v_lshlrev_b32 v1, 10, v0
    s_waitcnt vmcnt(0)
    s_barrier
    s_cmp_lg_u32 s52, 0
    s_cbranch_scc1 W0_3
    s_mov_b64 exec, 255
    buffer_atomic_swap v243, v1, s[40:43], s101 offen sc1
    s_mov_b64 exec, -1
W0_3:
    s_add_u32 s61, s52, s67
    s_add_u32 s61, s61, 4
    s_sub_u32 s62, s61, 10
    s_cmp_ge_u32 s61, 10
    s_cselect_b32 s61, s62, s61
    s_mul_i32 s62, s61, 245760
    s_mul_i32 s63, s55, 40
    s_add_u32 s62, s62, s63
    s_mul_i32 s63, s61, 9216
    s_add_u32 m0, s63, 0
    s_nop 0
    buffer_load_dwordx4 v224, s[8:11], s62 offen lds
    s_add_u32 m0, s63, 1024
    s_nop 0
    buffer_load_dwordx4 v225, s[8:11], s62 offen lds
    s_add_u32 m0, s63, 2048
    s_nop 0
    buffer_load_dwordx4 v226, s[8:11], s62 offen lds
    s_add_u32 m0, s63, 3072
    s_nop 0
    buffer_load_dwordx4 v227, s[8:11], s62 offen lds
    s_add_u32 m0, s63, 4096
    s_nop 0
    buffer_load_dwordx4 v228, s[8:11], s62 offen lds
    s_add_u32 m0, s63, 5120
    s_nop 0
    buffer_load_dwordx4 v229, s[8:11], s62 offen lds
    s_add_u32 m0, s63, 6144
    s_nop 0
    buffer_load_dwordx4 v230, s[8:11], s62 offen lds
    s_add_u32 m0, s63, 7168
    s_nop 0
    buffer_load_dwordx4 v231, s[8:11], s62 offen lds
    s_add_u32 m0, s63, 8192
    s_nop 0
    buffer_load_dwordx4 v232, s[8:11], s62 offen lds
    s_and_b32 s61, s52, 1
    s_add_u32 s61, s61, s67
    s_add_u32 s61, s61, 8
    s_sub_u32 s62, s61, 10
    s_cmp_ge_u32 s61, 10
    s_cselect_b32 s61, s62, s61
    s_mul_i32 s62, s61, 245760
    s_mul_i32 s63, s55, 40
    s_add_u32 s62, s62, s63
    s_mul_i32 s63, s61, 9216
    s_cmp_gt_u32 s52, 1
    s_cbranch_scc1 WH_6
    s_add_u32 m0, s63, 0
    s_nop 0
    buffer_load_dwordx4 v224, s[8:11], s62 offen lds
    s_add_u32 m0, s63, 1024
    s_nop 0
    buffer_load_dwordx4 v225, s[8:11], s62 offen lds
    s_add_u32 m0, s63, 2048
    s_nop 0
    buffer_load_dwordx4 v226, s[8:11], s62 offen lds
    s_add_u32 m0, s63, 3072
    s_nop 0
    buffer_load_dwordx4 v227, s[8:11], s62 offen lds
    s_add_u32 m0, s63, 4096
    s_nop 0
    buffer_load_dwordx4 v228, s[8:11], s62 offen lds
    s_branch WE_7
WH_6:
    s_add_u32 m0, s63, 5120
    s_nop 0
    buffer_load_dwordx4 v229, s[8:11], s62 offen lds
    s_add_u32 m0, s63, 6144
    s_nop 0
    buffer_load_dwordx4 v230, s[8:11], s62 offen lds
    s_add_u32 m0, s63, 7168
    s_nop 0
    buffer_load_dwordx4 v231, s[8:11], s62 offen lds
    s_add_u32 m0, s63, 8192
    s_nop 0
    buffer_load_dwordx4 v232, s[8:11], s62 offen lds
WE_7:
L_layer:
    v_lshrrev_b32 v8, 5, v0
    v_bfe_u32 v9, v0, 2, 2
    v_lshl_add_u32 v8, v8, 3, v9
    v_mul_u32_u24 v8, 144, v8
    v_and_b32 v9, 3, v0
    v_lshlrev_b32 v9, 3, v9
    v_and_b32 v10, 16, v0
    v_cmp_eq_u32 vcc, 0, v10
    v_mov_b32 v10, 0x68602050
    v_mov_b32 v11, 0x48384030
    v_cndmask_b32 v10, v10, v11, vcc
    v_lshrrev_b32 v10, v9, v10
    v_and_b32 v10, 0xff, v10
    v_add_u32 v4, v8, v10
    v_add_u32 v6, 46080, v4
    v_mov_b32 v10, 0x88807870
    v_mov_b32 v11, 0x18081000
    v_cndmask_b32 v10, v10, v11, vcc
    v_lshrrev_b32 v10, v9, v10
    v_and_b32 v10, 0xff, v10
    v_add_u32 v5, v8, v10
    v_add_u32 v7, 46080, v5
    s_lshl_b32 s61, s52, 8
    s_add_u32 s61, s61, 158208
    v_lshrrev_b32 v8, 5, v0
    v_lshlrev_b32 v8, 4, v8
    v_add_u32 v8, s61, v8
    v_lshlrev_b32 v9, 2, v0
    v_add_u32 v9, s61, v9
    v_mov_b32 v11, v9
    s_lshl_b32 s61, s54, 2
    s_add_u32 s61, s61, s52
    s_mul_i32 s84, s61, 81920
    s_mul_i32 s62, s53, 2621440
    s_add_u32 s84, s84, s62
    s_add_u32 s84, s84, 28311552
    v_lshlrev_b32 v2, 4, v0
    v_add_u32 v3, 40960, v2
    s_lshl_b32 s66, s61, 12
    s_mul_i32 s61, s53, 131072
    s_add_u32 s66, s66, s61
    s_add_u32 s66, s66, 65536
    v_and_b32 v9, 31, v0
    v_lshlrev_b32 v9, 6, v9
    v_and_b32 v10, 32, v0
    v_add_u32 v9, v9, v10
    s_cmp_eq_u32 s52, 0
    s_cbranch_scc1 L_xw0
    s_waitcnt vmcnt(0)
L_xw0:
    s_cmp_lg_u32 s52, 0
    s_cbranch_scc1 W0_8
    s_mov_b32 s82, 4194304
FW_9:
    buffer_load_dword v1, v240, s[40:43], s69 offen sc1
    s_sub_u32 s82, s82, 1
    s_cbranch_scc1 L_exit
    s_waitcnt vmcnt(0)
    v_cmp_ne_u32 vcc, s99, v1
    s_cbranch_vccnz FW_9
W0_8:
    s_barrier
    buffer_load_dwordx4 v[96:99], v2, s[40:43], s84 offen offset:0
    buffer_load_dwordx4 v[100:103], v3, s[40:43], s84 offen offset:0
    buffer_load_dwordx4 v[104:107], v2, s[40:43], s84 offen offset:1024
    buffer_load_dwordx4 v[108:111], v3, s[40:43], s84 offen offset:1024
    buffer_load_dwordx4 v[112:115], v2, s[40:43], s84 offen offset:2048
    buffer_load_dwordx4 v[116:119], v3, s[40:43], s84 offen offset:2048
    buffer_load_dwordx4 v[120:123], v2, s[40:43], s84 offen offset:3072
    buffer_load_dwordx4 v[124:127], v3, s[40:43], s84 offen offset:3072
    s_add_u32 s84, s84, 4096
    buffer_load_dwordx4 v[128:131], v2, s[40:43], s84 offen offset:0
    buffer_load_dwordx4 v[132:135], v3, s[40:43], s84 offen offset:0
    buffer_load_dwordx4 v[136:139], v2, s[40:43], s84 offen offset:1024
    buffer_load_dwordx4 v[140:143], v3, s[40:43], s84 offen offset:1024
    buffer_load_dwordx4 v[144:147], v2, s[40:43], s84 offen offset:2048
    buffer_load_dwordx4 v[148:151], v3, s[40:43], s84 offen offset:2048
    buffer_load_dwordx4 v[152:155], v2, s[40:43], s84 offen offset:3072
    buffer_load_dwordx4 v[156:159], v3, s[40:43], s84 offen offset:3072
    s_add_u32 s84, s84, 4096
    buffer_load_dwordx4 v[160:163], v2, s[40:43], s84 offen offset:0
    buffer_load_dwordx4 v[164:167], v3, s[40:43], s84 offen offset:0
    buffer_load_dwordx4 v[168:171], v2, s[40:43], s84 offen offset:1024
    buffer_load_dwordx4 v[172:175], v3, s[40:43], s84 offen offset:1024
    buffer_load_dwordx4 v[176:179], v2, s[40:43], s84 offen offset:2048
    buffer_load_dwordx4 v[180:183], v3, s[40:43], s84 offen offset:2048
    buffer_load_dwordx4 v[184:187], v2, s[40:43], s84 offen offset:3072
    buffer_load_dwordx4 v[188:191], v3, s[40:43], s84 offen offset:3072
    s_add_u32 s84, s84, 4096
    buffer_load_dwordx4 v[192:195], v2, s[40:43], s84 offen offset:0
    buffer_load_dwordx4 v[196:199], v3, s[40:43], s84 offen offset:0
    buffer_load_dwordx4 v[200:203], v2, s[40:43], s84 offen offset:1024
    buffer_load_dwordx4 v[204:207], v3, s[40:43], s84 offen offset:1024
    s_cmp_lg_u32 s53, 0
    s_cbranch_scc1 NOCW_10
    v_mov_b32 v12, 0x3f803f80
    v_mov_b32 v13, 0x3f803f80
    v_mov_b32 v14, 0x3f803f80
    v_mov_b32 v15, 0x3f803f80
    s_mul_i32 s62, s52, 23040
    v_add_u32 v10, s62, v4
    v_add_u32 v1, s62, v5
    ds_read_b64_tr_b16 v[48:49], v10 offset:0
    ds_read_b64_tr_b16 v[50:51], v10 offset:576
    ds_read_b64_tr_b16 v[52:53], v1 offset:0
    ds_read_b64_tr_b16 v[54:55], v1 offset:576
    ds_read_b64_tr_b16 v[56:57], v10 offset:2304
    ds_read_b64_tr_b16 v[58:59], v10 offset:2880
    ds_read_b64_tr_b16 v[60:61], v1 offset:2304
    ds_read_b64_tr_b16 v[62:63], v1 offset:2880
    ds_read_b64_tr_b16 v[64:65], v10 offset:4608
    ds_read_b64_tr_b16 v[66:67], v10 offset:5184
    ds_read_b64_tr_b16 v[68:69], v1 offset:4608
    ds_read_b64_tr_b16 v[70:71], v1 offset:5184
    ds_read_b64_tr_b16 v[72:73], v10 offset:6912
    ds_read_b64_tr_b16 v[74:75], v10 offset:7488
    ds_read_b64_tr_b16 v[76:77], v1 offset:6912
    ds_read_b64_tr_b16 v[78:79], v1 offset:7488
    s_waitcnt lgkmcnt(12)
    v_mfma_f32_32x32x16_bf16 v[16:31], v[48:51], v[12:15], 0
    v_mfma_f32_32x32x16_bf16 v[32:47], v[52:55], v[12:15], 0
    ds_read_b64_tr_b16 v[80:81], v10 offset:9216
    ds_read_b64_tr_b16 v[82:83], v10 offset:9792
    ds_read_b64_tr_b16 v[84:85], v1 offset:9216
    ds_read_b64_tr_b16 v[86:87], v1 offset:9792
    s_waitcnt lgkmcnt(12)
    v_mfma_f32_32x32x16_bf16 v[16:31], v[56:59], v[12:15], v[16:31]
    v_mfma_f32_32x32x16_bf16 v[32:47], v[60:63], v[12:15], v[32:47]
    ds_read_b64_tr_b16 v[88:89], v10 offset:11520
    ds_read_b64_tr_b16 v[90:91], v10 offset:12096
    ds_read_b64_tr_b16 v[92:93], v1 offset:11520
    ds_read_b64_tr_b16 v[94:95], v1 offset:12096
    s_waitcnt lgkmcnt(12)
    v_mfma_f32_32x32x16_bf16 v[16:31], v[64:67], v[12:15], v[16:31]
    v_mfma_f32_32x32x16_bf16 v[32:47], v[68:71], v[12:15], v[32:47]
    ds_read_b64_tr_b16 v[48:49], v10 offset:13824
    ds_read_b64_tr_b16 v[50:51], v10 offset:14400
    ds_read_b64_tr_b16 v[52:53], v1 offset:13824
    ds_read_b64_tr_b16 v[54:55], v1 offset:14400
    s_waitcnt lgkmcnt(12)
    v_mfma_f32_32x32x16_bf16 v[16:31], v[72:75], v[12:15], v[16:31]
    v_mfma_f32_32x32x16_bf16 v[32:47], v[76:79], v[12:15], v[32:47]
    ds_read_b64_tr_b16 v[56:57], v10 offset:16128
    ds_read_b64_tr_b16 v[58:59], v10 offset:16704
    ds_read_b64_tr_b16 v[60:61], v1 offset:16128
    ds_read_b64_tr_b16 v[62:63], v1 offset:16704
    s_waitcnt lgkmcnt(12)
    v_mfma_f32_32x32x16_bf16 v[16:31], v[80:83], v[12:15], v[16:31]
    v_mfma_f32_32x32x16_bf16 v[32:47], v[84:87], v[12:15], v[32:47]
    ds_read_b64_tr_b16 v[64:65], v10 offset:18432
    ds_read_b64_tr_b16 v[66:67], v10 offset:19008
    ds_read_b64_tr_b16 v[68:69], v1 offset:18432
    ds_read_b64_tr_b16 v[70:71], v1 offset:19008
    s_waitcnt lgkmcnt(12)
    v_mfma_f32_32x32x16_bf16 v[16:31], v[88:91], v[12:15], v[16:31]
    v_mfma_f32_32x32x16_bf16 v[32:47], v[92:95], v[12:15], v[32:47]
    ds_read_b64_tr_b16 v[72:73], v10 offset:20736
    ds_read_b64_tr_b16 v[74:75], v10 offset:21312
    ds_read_b64_tr_b16 v[76:77], v1 offset:20736
    ds_read_b64_tr_b16 v[78:79], v1 offset:21312
    s_waitcnt lgkmcnt(12)
    v_mfma_f32_32x32x16_bf16 v[16:31], v[48:51], v[12:15], v[16:31]
    v_mfma_f32_32x32x16_bf16 v[32:47], v[52:55], v[12:15], v[32:47]
    s_waitcnt lgkmcnt(8)
    v_mfma_f32_32x32x16_bf16 v[16:31], v[56:59], v[12:15], v[16:31]
    v_mfma_f32_32x32x16_bf16 v[32:47], v[60:63], v[12:15], v[32:47]
    s_waitcnt lgkmcnt(4)
    v_mfma_f32_32x32x16_bf16 v[16:31], v[64:67], v[12:15], v[16:31]
    v_mfma_f32_32x32x16_bf16 v[32:47], v[68:71], v[12:15], v[32:47]
    s_waitcnt lgkmcnt(0)
    v_mfma_f32_32x32x16_bf16 v[16:31], v[72:75], v[12:15], v[16:31]
    v_mfma_f32_32x32x16_bf16 v[32:47], v[76:79], v[12:15], v[32:47]
    s_nop 7
    v_subrev_u32 v62, 12800, v8
    v_lshlrev_b32 v63, 2, v0
    s_mov_b32 s70, 1
    s_mov_b32 s71, 1
    s_mov_b64 exec, s[70:71]
    ds_write_b128 v62, v[16:19] offset:0
    ds_write_b128 v62, v[20:23] offset:32
    ds_write_b128 v62, v[24:27] offset:64
    ds_write_b128 v62, v[28:31] offset:96
    ds_write_b128 v62, v[32:35] offset:128
    ds_write_b128 v62, v[36:39] offset:160
    ds_write_b128 v62, v[40:43] offset:192
    ds_write_b128 v62, v[44:47] offset:224
    s_mov_b64 exec, -1
    v_add_u32 v63, 145408, v63
    s_waitcnt lgkmcnt(0)
    s_barrier
    ds_read_b32 v64, v63
    ds_read_b32 v65, v63 offset:256
    ds_read_b32 v66, v63 offset:512
    ds_read_b32 v67, v63 offset:768
    s_waitcnt lgkmcnt(0)
    v_add_f32 v64, v64, v65
    v_add_f32 v66, v66, v67
    v_add_f32 v244, v64, v66
NOCW_10:
    ds_write_b32 v11, v244
    ds_read_b64_tr_b16 v[80:81], v4 offset:0
    ds_read_b64_tr_b16 v[82:83], v4 offset:576
    ds_read_b64_tr_b16 v[84:85], v5 offset:0
    ds_read_b64_tr_b16 v[86:87], v5 offset:576
    ds_read_b64_tr_b16 v[88:89], v4 offset:2304
    ds_read_b64_tr_b16 v[90:91], v4 offset:2880
    ds_read_b64_tr_b16 v[92:93], v5 offset:2304
    ds_read_b64_tr_b16 v[94:95], v5 offset:2880
    s_waitcnt vmcnt(26)
    s_waitcnt lgkmcnt(4)
    v_mfma_f32_32x32x16_bf16 v[16:31], v[80:83], v[96:99], 0
    v_mfma_f32_32x32x16_bf16 v[48:63], v[80:83], v[100:103], 0
    v_mfma_f32_32x32x16_bf16 v[32:47], v[84:87], v[96:99], 0
    v_mfma_f32_32x32x16_bf16 v[64:79], v[84:87], v[100:103], 0
    buffer_load_dwordx4 v[96:99], v2, s[40:43], s84 offen offset:2048
    buffer_load_dwordx4 v[100:103], v3, s[40:43], s84 offen offset:2048
    ds_read_b64_tr_b16 v[80:81], v4 offset:4608
    ds_read_b64_tr_b16 v[82:83], v4 offset:5184
    ds_read_b64_tr_b16 v[84:85], v5 offset:4608
    ds_read_b64_tr_b16 v[86:87], v5 offset:5184
    s_waitcnt vmcnt(26)
    s_waitcnt lgkmcnt(4)
    v_mfma_f32_32x32x16_bf16 v[16:31], v[88:91], v[104:107], v[16:31]
    v_mfma_f32_32x32x16_bf16 v[48:63], v[88:91], v[108:111], v[48:63]
    v_mfma_f32_32x32x16_bf16 v[32:47], v[92:95], v[104:107], v[32:47]
    v_mfma_f32_32x32x16_bf16 v[64:79], v[92:95], v[108:111], v[64:79]
    buffer_load_dwordx4 v[104:107], v2, s[40:43], s84 offen offset:3072
    buffer_load_dwordx4 v[108:111], v3, s[40:43], s84 offen offset:3072
    s_add_u32 s84, s84, 4096
    ds_read_b64_tr_b16 v[88:89], v4 offset:6912
    ds_read_b64_tr_b16 v[90:91], v4 offset:7488
    ds_read_b64_tr_b16 v[92:93], v5 offset:6912
    ds_read_b64_tr_b16 v[94:95], v5 offset:7488
    s_waitcnt vmcnt(26)
    s_waitcnt lgkmcnt(4)
    v_mfma_f32_32x32x16_bf16 v[16:31], v[80:83], v[112:115], v[16:31]
    v_mfma_f32_32x32x16_bf16 v[48:63], v[80:83], v[116:119], v[48:63]
    v_mfma_f32_32x32x16_bf16 v[32:47], v[84:87], v[112:115], v[32:47]
    v_mfma_f32_32x32x16_bf16 v[64:79], v[84:87], v[116:119], v[64:79]
    buffer_load_dwordx4 v[112:115], v2, s[40:43], s84 offen offset:0
    buffer_load_dwordx4 v[116:119], v3, s[40:43], s84 offen offset:0
    ds_read_b64_tr_b16 v[80:81], v4 offset:9216
    ds_read_b64_tr_b16 v[82:83], v4 offset:9792
    ds_read_b64_tr_b16 v[84:85], v5 offset:9216
    ds_read_b64_tr_b16 v[86:87], v5 offset:9792
    s_waitcnt vmcnt(26)
    s_waitcnt lgkmcnt(4)
    v_mfma_f32_32x32x16_bf16 v[16:31], v[88:91], v[120:123], v[16:31]
    v_mfma_f32_32x32x16_bf16 v[48:63], v[88:91], v[124:127], v[48:63]
    v_mfma_f32_32x32x16_bf16 v[32:47], v[92:95], v[120:123], v[32:47]
    v_mfma_f32_32x32x16_bf16 v[64:79], v[92:95], v[124:127], v[64:79]
    buffer_load_dwordx4 v[120:123], v2, s[40:43], s84 offen offset:1024
    buffer_load_dwordx4 v[124:127], v3, s[40:43], s84 offen offset:1024
    ds_read_b64_tr_b16 v[88:89], v4 offset:11520
    ds_read_b64_tr_b16 v[90:91], v4 offset:12096
    ds_read_b64_tr_b16 v[92:93], v5 offset:11520
    ds_read_b64_tr_b16 v[94:95], v5 offset:12096
    s_waitcnt vmcnt(26)
    s_waitcnt lgkmcnt(4)
    v_mfma_f32_32x32x16_bf16 v[16:31], v[80:83], v[128:131], v[16:31]
    v_mfma_f32_32x32x16_bf16 v[48:63], v[80:83], v[132:135], v[48:63]
    v_mfma_f32_32x32x16_bf16 v[32:47], v[84:87], v[128:131], v[32:47]
    v_mfma_f32_32x32x16_bf16 v[64:79], v[84:87], v[132:135], v[64:79]
    buffer_load_dwordx4 v[128:131], v2, s[40:43], s84 offen offset:2048
    buffer_load_dwordx4 v[132:135], v3, s[40:43], s84 offen offset:2048
    ds_read_b64_tr_b16 v[80:81], v4 offset:13824
    ds_read_b64_tr_b16 v[82:83], v4 offset:14400
    ds_read_b64_tr_b16 v[84:85], v5 offset:13824
    ds_read_b64_tr_b16 v[86:87], v5 offset:14400
    s_waitcnt vmcnt(26)
    s_waitcnt lgkmcnt(4)
    v_mfma_f32_32x32x16_bf16 v[16:31], v[88:91], v[136:139], v[16:31]
    v_mfma_f32_32x32x16_bf16 v[48:63], v[88:91], v[140:143], v[48:63]
    v_mfma_f32_32x32x16_bf16 v[32:47], v[92:95], v[136:139], v[32:47]
    v_mfma_f32_32x32x16_bf16 v[64:79], v[92:95], v[140:143], v[64:79]
    buffer_load_dwordx4 v[136:139], v2, s[40:43], s84 offen offset:3072
    buffer_load_dwordx4 v[140:143], v3, s[40:43], s84 offen offset:3072
    s_add_u32 s84, s84, 4096
    ds_read_b64_tr_b16 v[88:89], v4 offset:16128
    ds_read_b64_tr_b16 v[90:91], v4 offset:16704
    ds_read_b64_tr_b16 v[92:93], v5 offset:16128
    ds_read_b64_tr_b16 v[94:95], v5 offset:16704
    s_waitcnt vmcnt(26)
    s_waitcnt lgkmcnt(4)
    v_mfma_f32_32x32x16_bf16 v[16:31], v[80:83], v[144:147], v[16:31]
    v_mfma_f32_32x32x16_bf16 v[48:63], v[80:83], v[148:151], v[48:63]
    v_mfma_f32_32x32x16_bf16 v[32:47], v[84:87], v[144:147], v[32:47]
    v_mfma_f32_32x32x16_bf16 v[64:79], v[84:87], v[148:151], v[64:79]
    buffer_load_dwordx4 v[144:147], v2, s[40:43], s84 offen offset:0
    buffer_load_dwordx4 v[148:151], v3, s[40:43], s84 offen offset:0
    ds_read_b64_tr_b16 v[80:81], v4 offset:18432
    ds_read_b64_tr_b16 v[82:83], v4 offset:19008
    ds_read_b64_tr_b16 v[84:85], v5 offset:18432
    ds_read_b64_tr_b16 v[86:87], v5 offset:19008
    s_waitcnt vmcnt(26)
    s_waitcnt lgkmcnt(4)
    v_mfma_f32_32x32x16_bf16 v[16:31], v[88:91], v[152:155], v[16:31]
    v_mfma_f32_32x32x16_bf16 v[48:63], v[88:91], v[156:159], v[48:63]
    v_mfma_f32_32x32x16_bf16 v[32:47], v[92:95], v[152:155], v[32:47]
    v_mfma_f32_32x32x16_bf16 v[64:79], v[92:95], v[156:159], v[64:79]
    buffer_load_dwordx4 v[152:155], v2, s[40:43], s84 offen offset:1024
    buffer_load_dwordx4 v[156:159], v3, s[40:43], s84 offen offset:1024
    ds_read_b64_tr_b16 v[88:89], v4 offset:20736
    ds_read_b64_tr_b16 v[90:91], v4 offset:21312
    ds_read_b64_tr_b16 v[92:93], v5 offset:20736
    ds_read_b64_tr_b16 v[94:95], v5 offset:21312
    s_waitcnt vmcnt(26)
    s_waitcnt lgkmcnt(4)
    v_mfma_f32_32x32x16_bf16 v[16:31], v[80:83], v[160:163], v[16:31]
    v_mfma_f32_32x32x16_bf16 v[48:63], v[80:83], v[164:167], v[48:63]
    v_mfma_f32_32x32x16_bf16 v[32:47], v[84:87], v[160:163], v[32:47]
    v_mfma_f32_32x32x16_bf16 v[64:79], v[84:87], v[164:167], v[64:79]
    buffer_load_dwordx4 v[160:163], v2, s[40:43], s84 offen offset:2048
    buffer_load_dwordx4 v[164:167], v3, s[40:43], s84 offen offset:2048
    ds_read_b64_tr_b16 v[80:81], v4 offset:23040
    ds_read_b64_tr_b16 v[82:83], v4 offset:23616
    ds_read_b64_tr_b16 v[84:85], v5 offset:23040
    ds_read_b64_tr_b16 v[86:87], v5 offset:23616
    s_waitcnt vmcnt(26)
    s_waitcnt lgkmcnt(4)
    v_mfma_f32_32x32x16_bf16 v[16:31], v[88:91], v[168:171], v[16:31]
    v_mfma_f32_32x32x16_bf16 v[48:63], v[88:91], v[172:175], v[48:63]
    v_mfma_f32_32x32x16_bf16 v[32:47], v[92:95], v[168:171], v[32:47]
    v_mfma_f32_32x32x16_bf16 v[64:79], v[92:95], v[172:175], v[64:79]
    buffer_load_dwordx4 v[168:171], v2, s[40:43], s84 offen offset:3072
    buffer_load_dwordx4 v[172:175], v3, s[40:43], s84 offen offset:3072
    s_add_u32 s84, s84, 4096
    ds_read_b64_tr_b16 v[88:89], v4 offset:25344
    ds_read_b64_tr_b16 v[90:91], v4 offset:25920
    ds_read_b64_tr_b16 v[92:93], v5 offset:25344
    ds_read_b64_tr_b16 v[94:95], v5 offset:25920
    s_waitcnt vmcnt(26)
    s_waitcnt lgkmcnt(4)
    v_mfma_f32_32x32x16_bf16 v[16:31], v[80:83], v[176:179], v[16:31]
    v_mfma_f32_32x32x16_bf16 v[48:63], v[80:83], v[180:183], v[48:63]
    v_mfma_f32_32x32x16_bf16 v[32:47], v[84:87], v[176:179], v[32:47]
    v_mfma_f32_32x32x16_bf16 v[64:79], v[84:87], v[180:183], v[64:79]
    buffer_load_dwordx4 v[176:179], v2, s[40:43], s84 offen offset:0
    buffer_load_dwordx4 v[180:183], v3, s[40:43], s84 offen offset:0
    ds_read_b64_tr_b16 v[80:81], v4 offset:27648
    ds_read_b64_tr_b16 v[82:83], v4 offset:28224
    ds_read_b64_tr_b16 v[84:85], v5 offset:27648
    ds_read_b64_tr_b16 v[86:87], v5 offset:28224
    s_waitcnt vmcnt(26)
    s_waitcnt lgkmcnt(4)
    v_mfma_f32_32x32x16_bf16 v[16:31], v[88:91], v[184:187], v[16:31]
    v_mfma_f32_32x32x16_bf16 v[48:63], v[88:91], v[188:191], v[48:63]
    v_mfma_f32_32x32x16_bf16 v[32:47], v[92:95], v[184:187], v[32:47]
    v_mfma_f32_32x32x16_bf16 v[64:79], v[92:95], v[188:191], v[64:79]
    buffer_load_dwordx4 v[184:187], v2, s[40:43], s84 offen offset:1024
    buffer_load_dwordx4 v[188:191], v3, s[40:43], s84 offen offset:1024
    ds_read_b64_tr_b16 v[88:89], v4 offset:29952
    ds_read_b64_tr_b16 v[90:91], v4 offset:30528
    ds_read_b64_tr_b16 v[92:93], v5 offset:29952
    ds_read_b64_tr_b16 v[94:95], v5 offset:30528
    s_waitcnt vmcnt(26)
    s_waitcnt lgkmcnt(4)
    v_mfma_f32_32x32x16_bf16 v[16:31], v[80:83], v[192:195], v[16:31]
    v_mfma_f32_32x32x16_bf16 v[48:63], v[80:83], v[196:199], v[48:63]
    v_mfma_f32_32x32x16_bf16 v[32:47], v[84:87], v[192:195], v[32:47]
    v_mfma_f32_32x32x16_bf16 v[64:79], v[84:87], v[196:199], v[64:79]
    buffer_load_dwordx4 v[192:195], v2, s[40:43], s84 offen offset:2048
    buffer_load_dwordx4 v[196:199], v3, s[40:43], s84 offen offset:2048
    ds_read_b64_tr_b16 v[80:81], v4 offset:32256
    ds_read_b64_tr_b16 v[82:83], v4 offset:32832
    ds_read_b64_tr_b16 v[84:85], v5 offset:32256
    ds_read_b64_tr_b16 v[86:87], v5 offset:32832
    s_waitcnt vmcnt(26)
    s_waitcnt lgkmcnt(4)
    v_mfma_f32_32x32x16_bf16 v[16:31], v[88:91], v[200:203], v[16:31]
    v_mfma_f32_32x32x16_bf16 v[48:63], v[88:91], v[204:207], v[48:63]
    v_mfma_f32_32x32x16_bf16 v[32:47], v[92:95], v[200:203], v[32:47]
    v_mfma_f32_32x32x16_bf16 v[64:79], v[92:95], v[204:207], v[64:79]
    buffer_load_dwordx4 v[200:203], v2, s[40:43], s84 offen offset:3072
    buffer_load_dwordx4 v[204:207], v3, s[40:43], s84 offen offset:3072
    s_add_u32 s84, s84, 4096
    ds_read_b64_tr_b16 v[88:89], v4 offset:34560
    ds_read_b64_tr_b16 v[90:91], v4 offset:35136
    ds_read_b64_tr_b16 v[92:93], v5 offset:34560
    ds_read_b64_tr_b16 v[94:95], v5 offset:35136
    s_waitcnt vmcnt(26)
    s_waitcnt lgkmcnt(4)
    v_mfma_f32_32x32x16_bf16 v[16:31], v[80:83], v[96:99], v[16:31]
    v_mfma_f32_32x32x16_bf16 v[48:63], v[80:83], v[100:103], v[48:63]
    v_mfma_f32_32x32x16_bf16 v[32:47], v[84:87], v[96:99], v[32:47]
    v_mfma_f32_32x32x16_bf16 v[64:79], v[84:87], v[100:103], v[64:79]
    buffer_load_dwordx4 v[96:99], v2, s[40:43], s84 offen offset:0
    buffer_load_dwordx4 v[100:103], v3, s[40:43], s84 offen offset:0
    ds_read_b64_tr_b16 v[80:81], v4 offset:36864
    ds_read_b64_tr_b16 v[82:83], v4 offset:37440
    ds_read_b64_tr_b16 v[84:85], v5 offset:36864
    ds_read_b64_tr_b16 v[86:87], v5 offset:37440
    s_waitcnt vmcnt(26)
    s_waitcnt lgkmcnt(4)
    v_mfma_f32_32x32x16_bf16 v[16:31], v[88:91], v[104:107], v[16:31]
    v_mfma_f32_32x32x16_bf16 v[48:63], v[88:91], v[108:111], v[48:63]
    v_mfma_f32_32x32x16_bf16 v[32:47], v[92:95], v[104:107], v[32:47]
    v_mfma_f32_32x32x16_bf16 v[64:79], v[92:95], v[108:111], v[64:79]
    buffer_load_dwordx4 v[104:107], v2, s[40:43], s84 offen offset:1024
    buffer_load_dwordx4 v[108:111], v3, s[40:43], s84 offen offset:1024
    ds_read_b64_tr_b16 v[88:89], v4 offset:39168
    ds_read_b64_tr_b16 v[90:91], v4 offset:39744
    ds_read_b64_tr_b16 v[92:93], v5 offset:39168
    ds_read_b64_tr_b16 v[94:95], v5 offset:39744
    s_waitcnt vmcnt(26)
    s_waitcnt lgkmcnt(4)
    v_mfma_f32_32x32x16_bf16 v[16:31], v[80:83], v[112:115], v[16:31]
    v_mfma_f32_32x32x16_bf16 v[48:63], v[80:83], v[116:119], v[48:63]
    v_mfma_f32_32x32x16_bf16 v[32:47], v[84:87], v[112:115], v[32:47]
    v_mfma_f32_32x32x16_bf16 v[64:79], v[84:87], v[116:119], v[64:79]
    buffer_load_dwordx4 v[112:115], v2, s[40:43], s84 offen offset:2048
    buffer_load_dwordx4 v[116:119], v3, s[40:43], s84 offen offset:2048
    ds_read_b64_tr_b16 v[80:81], v4 offset:41472
    ds_read_b64_tr_b16 v[82:83], v4 offset:42048
    ds_read_b64_tr_b16 v[84:85], v5 offset:41472
    ds_read_b64_tr_b16 v[86:87], v5 offset:42048
    s_waitcnt vmcnt(26)
    s_waitcnt lgkmcnt(4)
    v_mfma_f32_32x32x16_bf16 v[16:31], v[88:91], v[120:123], v[16:31]
    v_mfma_f32_32x32x16_bf16 v[48:63], v[88:91], v[124:127], v[48:63]
    v_mfma_f32_32x32x16_bf16 v[32:47], v[92:95], v[120:123], v[32:47]
    v_mfma_f32_32x32x16_bf16 v[64:79], v[92:95], v[124:127], v[64:79]
    buffer_load_dwordx4 v[120:123], v2, s[40:43], s84 offen offset:3072
    buffer_load_dwordx4 v[124:127], v3, s[40:43], s84 offen offset:3072
    s_add_u32 s84, s84, 4096
    ds_read_b64_tr_b16 v[88:89], v4 offset:43776
    ds_read_b64_tr_b16 v[90:91], v4 offset:44352
    ds_read_b64_tr_b16 v[92:93], v5 offset:43776
    ds_read_b64_tr_b16 v[94:95], v5 offset:44352
    s_waitcnt vmcnt(26)
    s_waitcnt lgkmcnt(4)
    v_mfma_f32_32x32x16_bf16 v[16:31], v[80:83], v[128:131], v[16:31]
    v_mfma_f32_32x32x16_bf16 v[48:63], v[80:83], v[132:135], v[48:63]
    v_mfma_f32_32x32x16_bf16 v[32:47], v[84:87], v[128:131], v[32:47]
    v_mfma_f32_32x32x16_bf16 v[64:79], v[84:87], v[132:135], v[64:79]
    buffer_load_dwordx4 v[128:131], v2, s[40:43], s84 offen offset:0
    buffer_load_dwordx4 v[132:135], v3, s[40:43], s84 offen offset:0
    ds_read_b64_tr_b16 v[80:81], v6 offset:0
    ds_read_b64_tr_b16 v[82:83], v6 offset:576
    ds_read_b64_tr_b16 v[84:85], v7 offset:0
    ds_read_b64_tr_b16 v[86:87], v7 offset:576
    s_waitcnt vmcnt(26)
    s_waitcnt lgkmcnt(4)
    v_mfma_f32_32x32x16_bf16 v[16:31], v[88:91], v[136:139], v[16:31]
    v_mfma_f32_32x32x16_bf16 v[48:63], v[88:91], v[140:143], v[48:63]
    v_mfma_f32_32x32x16_bf16 v[32:47], v[92:95], v[136:139], v[32:47]
    v_mfma_f32_32x32x16_bf16 v[64:79], v[92:95], v[140:143], v[64:79]
    buffer_load_dwordx4 v[136:139], v2, s[40:43], s84 offen offset:1024
    buffer_load_dwordx4 v[140:143], v3, s[40:43], s84 offen offset:1024
    ds_read_b64_tr_b16 v[88:89], v6 offset:2304
    ds_read_b64_tr_b16 v[90:91], v6 offset:2880
    ds_read_b64_tr_b16 v[92:93], v7 offset:2304
    ds_read_b64_tr_b16 v[94:95], v7 offset:2880
    s_waitcnt vmcnt(26)
    s_waitcnt lgkmcnt(4)
    v_mfma_f32_32x32x16_bf16 v[16:31], v[80:83], v[144:147], v[16:31]
    v_mfma_f32_32x32x16_bf16 v[48:63], v[80:83], v[148:151], v[48:63]
    v_mfma_f32_32x32x16_bf16 v[32:47], v[84:87], v[144:147], v[32:47]
    v_mfma_f32_32x32x16_bf16 v[64:79], v[84:87], v[148:151], v[64:79]
    buffer_load_dwordx4 v[144:147], v2, s[40:43], s84 offen offset:2048
    buffer_load_dwordx4 v[148:151], v3, s[40:43], s84 offen offset:2048
    ds_read_b64_tr_b16 v[80:81], v6 offset:4608
    ds_read_b64_tr_b16 v[82:83], v6 offset:5184
    ds_read_b64_tr_b16 v[84:85], v7 offset:4608
    ds_read_b64_tr_b16 v[86:87], v7 offset:5184
    s_waitcnt vmcnt(26)
    s_waitcnt lgkmcnt(4)
    v_mfma_f32_32x32x16_bf16 v[16:31], v[88:91], v[152:155], v[16:31]
    v_mfma_f32_32x32x16_bf16 v[48:63], v[88:91], v[156:159], v[48:63]
    v_mfma_f32_32x32x16_bf16 v[32:47], v[92:95], v[152:155], v[32:47]
    v_mfma_f32_32x32x16_bf16 v[64:79], v[92:95], v[156:159], v[64:79]
    buffer_load_dwordx4 v[152:155], v2, s[40:43], s84 offen offset:3072
    buffer_load_dwordx4 v[156:159], v3, s[40:43], s84 offen offset:3072
    s_add_u32 s84, s84, 4096
    ds_read_b64_tr_b16 v[88:89], v6 offset:6912
    ds_read_b64_tr_b16 v[90:91], v6 offset:7488
    ds_read_b64_tr_b16 v[92:93], v7 offset:6912
    ds_read_b64_tr_b16 v[94:95], v7 offset:7488
    s_waitcnt vmcnt(26)
    s_waitcnt lgkmcnt(4)
    v_mfma_f32_32x32x16_bf16 v[16:31], v[80:83], v[160:163], v[16:31]
    v_mfma_f32_32x32x16_bf16 v[48:63], v[80:83], v[164:167], v[48:63]
    v_mfma_f32_32x32x16_bf16 v[32:47], v[84:87], v[160:163], v[32:47]
    v_mfma_f32_32x32x16_bf16 v[64:79], v[84:87], v[164:167], v[64:79]
    buffer_load_dwordx4 v[160:163], v2, s[40:43], s84 offen offset:0
    buffer_load_dwordx4 v[164:167], v3, s[40:43], s84 offen offset:0
    ds_read_b64_tr_b16 v[80:81], v6 offset:9216
    ds_read_b64_tr_b16 v[82:83], v6 offset:9792
    ds_read_b64_tr_b16 v[84:85], v7 offset:9216
    ds_read_b64_tr_b16 v[86:87], v7 offset:9792
    s_waitcnt vmcnt(26)
    s_waitcnt lgkmcnt(4)
    v_mfma_f32_32x32x16_bf16 v[16:31], v[88:91], v[168:171], v[16:31]
    v_mfma_f32_32x32x16_bf16 v[48:63], v[88:91], v[172:175], v[48:63]
    v_mfma_f32_32x32x16_bf16 v[32:47], v[92:95], v[168:171], v[32:47]
    v_mfma_f32_32x32x16_bf16 v[64:79], v[92:95], v[172:175], v[64:79]
    buffer_load_dwordx4 v[168:171], v2, s[40:43], s84 offen offset:1024
    buffer_load_dwordx4 v[172:175], v3, s[40:43], s84 offen offset:1024
    ds_read_b64_tr_b16 v[88:89], v6 offset:11520
    ds_read_b64_tr_b16 v[90:91], v6 offset:12096
    ds_read_b64_tr_b16 v[92:93], v7 offset:11520
    ds_read_b64_tr_b16 v[94:95], v7 offset:12096
    s_waitcnt vmcnt(26)
    s_waitcnt lgkmcnt(4)
    v_mfma_f32_32x32x16_bf16 v[16:31], v[80:83], v[176:179], v[16:31]
    v_mfma_f32_32x32x16_bf16 v[48:63], v[80:83], v[180:183], v[48:63]
    v_mfma_f32_32x32x16_bf16 v[32:47], v[84:87], v[176:179], v[32:47]
    v_mfma_f32_32x32x16_bf16 v[64:79], v[84:87], v[180:183], v[64:79]
    buffer_load_dwordx4 v[176:179], v2, s[40:43], s84 offen offset:2048
    buffer_load_dwordx4 v[180:183], v3, s[40:43], s84 offen offset:2048
    ds_read_b64_tr_b16 v[80:81], v6 offset:13824
    ds_read_b64_tr_b16 v[82:83], v6 offset:14400
    ds_read_b64_tr_b16 v[84:85], v7 offset:13824
    ds_read_b64_tr_b16 v[86:87], v7 offset:14400
    s_waitcnt vmcnt(26)
    s_waitcnt lgkmcnt(4)
    v_mfma_f32_32x32x16_bf16 v[16:31], v[88:91], v[184:187], v[16:31]
    v_mfma_f32_32x32x16_bf16 v[48:63], v[88:91], v[188:191], v[48:63]
    v_mfma_f32_32x32x16_bf16 v[32:47], v[92:95], v[184:187], v[32:47]
    v_mfma_f32_32x32x16_bf16 v[64:79], v[92:95], v[188:191], v[64:79]
    buffer_load_dwordx4 v[184:187], v2, s[40:43], s84 offen offset:3072
    buffer_load_dwordx4 v[188:191], v3, s[40:43], s84 offen offset:3072
    s_add_u32 s84, s84, 4096
    ds_read_b64_tr_b16 v[88:89], v6 offset:16128
    ds_read_b64_tr_b16 v[90:91], v6 offset:16704
    ds_read_b64_tr_b16 v[92:93], v7 offset:16128
    ds_read_b64_tr_b16 v[94:95], v7 offset:16704
    s_waitcnt vmcnt(26)
    s_waitcnt lgkmcnt(4)
    v_mfma_f32_32x32x16_bf16 v[16:31], v[80:83], v[192:195], v[16:31]
    v_mfma_f32_32x32x16_bf16 v[48:63], v[80:83], v[196:199], v[48:63]
    v_mfma_f32_32x32x16_bf16 v[32:47], v[84:87], v[192:195], v[32:47]
    v_mfma_f32_32x32x16_bf16 v[64:79], v[84:87], v[196:199], v[64:79]
    buffer_load_dwordx4 v[208:211], v9, s[40:43], s66 offen offset:0
    buffer_load_dwordx4 v[212:215], v9, s[40:43], s66 offen offset:16
    buffer_load_dwordx4 v[216:219], v9, s[40:43], s66 offen offset:2048
    buffer_load_dwordx4 v[220:223], v9, s[40:43], s66 offen offset:2064
    ds_read_b64_tr_b16 v[80:81], v6 offset:18432
    ds_read_b64_tr_b16 v[82:83], v6 offset:19008
    ds_read_b64_tr_b16 v[84:85], v7 offset:18432
    ds_read_b64_tr_b16 v[86:87], v7 offset:19008
    s_waitcnt vmcnt(28)
    s_waitcnt lgkmcnt(4)
    v_mfma_f32_32x32x16_bf16 v[16:31], v[88:91], v[200:203], v[16:31]
    v_mfma_f32_32x32x16_bf16 v[48:63], v[88:91], v[204:207], v[48:63]
    v_mfma_f32_32x32x16_bf16 v[32:47], v[92:95], v[200:203], v[32:47]
    v_mfma_f32_32x32x16_bf16 v[64:79], v[92:95], v[204:207], v[64:79]
    ds_read_b64_tr_b16 v[88:89], v6 offset:20736
    ds_read_b64_tr_b16 v[90:91], v6 offset:21312
    ds_read_b64_tr_b16 v[92:93], v7 offset:20736
    ds_read_b64_tr_b16 v[94:95], v7 offset:21312
    s_waitcnt vmcnt(26)
    s_waitcnt lgkmcnt(4)
    v_mfma_f32_32x32x16_bf16 v[16:31], v[80:83], v[96:99], v[16:31]
    v_mfma_f32_32x32x16_bf16 v[48:63], v[80:83], v[100:103], v[48:63]
    v_mfma_f32_32x32x16_bf16 v[32:47], v[84:87], v[96:99], v[32:47]
    v_mfma_f32_32x32x16_bf16 v[64:79], v[84:87], v[100:103], v[64:79]
    ds_read_b64_tr_b16 v[80:81], v6 offset:23040
    ds_read_b64_tr_b16 v[82:83], v6 offset:23616
    ds_read_b64_tr_b16 v[84:85], v7 offset:23040
    ds_read_b64_tr_b16 v[86:87], v7 offset:23616
    s_waitcnt vmcnt(24)
    s_waitcnt lgkmcnt(4)
    v_mfma_f32_32x32x16_bf16 v[16:31], v[88:91], v[104:107], v[16:31]
    v_mfma_f32_32x32x16_bf16 v[48:63], v[88:91], v[108:111], v[48:63]
    v_mfma_f32_32x32x16_bf16 v[32:47], v[92:95], v[104:107], v[32:47]
    v_mfma_f32_32x32x16_bf16 v[64:79], v[92:95], v[108:111], v[64:79]
    ds_read_b64_tr_b16 v[88:89], v6 offset:25344
    ds_read_b64_tr_b16 v[90:91], v6 offset:25920
    ds_read_b64_tr_b16 v[92:93], v7 offset:25344
    ds_read_b64_tr_b16 v[94:95], v7 offset:25920
    s_waitcnt vmcnt(22)
    s_waitcnt lgkmcnt(4)
    v_mfma_f32_32x32x16_bf16 v[16:31], v[80:83], v[112:115], v[16:31]
    v_mfma_f32_32x32x16_bf16 v[48:63], v[80:83], v[116:119], v[48:63]
    v_mfma_f32_32x32x16_bf16 v[32:47], v[84:87], v[112:115], v[32:47]
    v_mfma_f32_32x32x16_bf16 v[64:79], v[84:87], v[116:119], v[64:79]
    ds_read_b64_tr_b16 v[80:81], v6 offset:27648
    ds_read_b64_tr_b16 v[82:83], v6 offset:28224
    ds_read_b64_tr_b16 v[84:85], v7 offset:27648
    ds_read_b64_tr_b16 v[86:87], v7 offset:28224
    s_waitcnt vmcnt(20)
    s_waitcnt lgkmcnt(4)
    v_mfma_f32_32x32x16_bf16 v[16:31], v[88:91], v[120:123], v[16:31]
    v_mfma_f32_32x32x16_bf16 v[48:63], v[88:91], v[124:127], v[48:63]
    v_mfma_f32_32x32x16_bf16 v[32:47], v[92:95], v[120:123], v[32:47]
    v_mfma_f32_32x32x16_bf16 v[64:79], v[92:95], v[124:127], v[64:79]
    ds_read_b64_tr_b16 v[88:89], v6 offset:29952
    ds_read_b64_tr_b16 v[90:91], v6 offset:30528
    ds_read_b64_tr_b16 v[92:93], v7 offset:29952
    ds_read_b64_tr_b16 v[94:95], v7 offset:30528
    s_waitcnt vmcnt(18)
    s_waitcnt lgkmcnt(4)
    v_mfma_f32_32x32x16_bf16 v[16:31], v[80:83], v[128:131], v[16:31]
    v_mfma_f32_32x32x16_bf16 v[48:63], v[80:83], v[132:135], v[48:63]
    v_mfma_f32_32x32x16_bf16 v[32:47], v[84:87], v[128:131], v[32:47]
    v_mfma_f32_32x32x16_bf16 v[64:79], v[84:87], v[132:135], v[64:79]
    ds_read_b64_tr_b16 v[80:81], v6 offset:32256
    ds_read_b64_tr_b16 v[82:83], v6 offset:32832
    ds_read_b64_tr_b16 v[84:85], v7 offset:32256
    ds_read_b64_tr_b16 v[86:87], v7 offset:32832
    s_waitcnt vmcnt(16)
    s_waitcnt lgkmcnt(4)
    v_mfma_f32_32x32x16_bf16 v[16:31], v[88:91], v[136:139], v[16:31]
    v_mfma_f32_32x32x16_bf16 v[48:63], v[88:91], v[140:143], v[48:63]
    v_mfma_f32_32x32x16_bf16 v[32:47], v[92:95], v[136:139], v[32:47]
    v_mfma_f32_32x32x16_bf16 v[64:79], v[92:95], v[140:143], v[64:79]
    ds_read_b64_tr_b16 v[88:89], v6 offset:34560
    ds_read_b64_tr_b16 v[90:91], v6 offset:35136
    ds_read_b64_tr_b16 v[92:93], v7 offset:34560
    ds_read_b64_tr_b16 v[94:95], v7 offset:35136
    s_waitcnt vmcnt(14)
    s_waitcnt lgkmcnt(4)
    v_mfma_f32_32x32x16_bf16 v[16:31], v[80:83], v[144:147], v[16:31]
    v_mfma_f32_32x32x16_bf16 v[48:63], v[80:83], v[148:151], v[48:63]
    v_mfma_f32_32x32x16_bf16 v[32:47], v[84:87], v[144:147], v[32:47]
    v_mfma_f32_32x32x16_bf16 v[64:79], v[84:87], v[148:151], v[64:79]
    ds_read_b64_tr_b16 v[80:81], v6 offset:36864
    ds_read_b64_tr_b16 v[82:83], v6 offset:37440
    ds_read_b64_tr_b16 v[84:85], v7 offset:36864
    ds_read_b64_tr_b16 v[86:87], v7 offset:37440
    s_waitcnt vmcnt(12)
    s_waitcnt lgkmcnt(4)
    v_mfma_f32_32x32x16_bf16 v[16:31], v[88:91], v[152:155], v[16:31]
    v_mfma_f32_32x32x16_bf16 v[48:63], v[88:91], v[156:159], v[48:63]
    v_mfma_f32_32x32x16_bf16 v[32:47], v[92:95], v[152:155], v[32:47]
    v_mfma_f32_32x32x16_bf16 v[64:79], v[92:95], v[156:159], v[64:79]
    ds_read_b64_tr_b16 v[88:89], v6 offset:39168
    ds_read_b64_tr_b16 v[90:91], v6 offset:39744
    ds_read_b64_tr_b16 v[92:93], v7 offset:39168
    ds_read_b64_tr_b16 v[94:95], v7 offset:39744
    s_waitcnt vmcnt(10)
    s_waitcnt lgkmcnt(4)
    v_mfma_f32_32x32x16_bf16 v[16:31], v[80:83], v[160:163], v[16:31]
    v_mfma_f32_32x32x16_bf16 v[48:63], v[80:83], v[164:167], v[48:63]
    v_mfma_f32_32x32x16_bf16 v[32:47], v[84:87], v[160:163], v[32:47]
    v_mfma_f32_32x32x16_bf16 v[64:79], v[84:87], v[164:167], v[64:79]
    ds_read_b64_tr_b16 v[80:81], v6 offset:41472
    ds_read_b64_tr_b16 v[82:83], v6 offset:42048
    ds_read_b64_tr_b16 v[84:85], v7 offset:41472
    ds_read_b64_tr_b16 v[86:87], v7 offset:42048
    s_waitcnt vmcnt(8)
    s_waitcnt lgkmcnt(4)
    v_mfma_f32_32x32x16_bf16 v[16:31], v[88:91], v[168:171], v[16:31]
    v_mfma_f32_32x32x16_bf16 v[48:63], v[88:91], v[172:175], v[48:63]
    v_mfma_f32_32x32x16_bf16 v[32:47], v[92:95], v[168:171], v[32:47]
    v_mfma_f32_32x32x16_bf16 v[64:79], v[92:95], v[172:175], v[64:79]
    ds_read_b64_tr_b16 v[88:89], v6 offset:43776
    ds_read_b64_tr_b16 v[90:91], v6 offset:44352
    ds_read_b64_tr_b16 v[92:93], v7 offset:43776
    ds_read_b64_tr_b16 v[94:95], v7 offset:44352
    s_waitcnt vmcnt(6)
    s_waitcnt lgkmcnt(4)
    v_mfma_f32_32x32x16_bf16 v[16:31], v[80:83], v[176:179], v[16:31]
    v_mfma_f32_32x32x16_bf16 v[48:63], v[80:83], v[180:183], v[48:63]
    v_mfma_f32_32x32x16_bf16 v[32:47], v[84:87], v[176:179], v[32:47]
    v_mfma_f32_32x32x16_bf16 v[64:79], v[84:87], v[180:183], v[64:79]
    s_waitcnt vmcnt(4)
    s_waitcnt lgkmcnt(0)
    v_mfma_f32_32x32x16_bf16 v[16:31], v[88:91], v[184:187], v[16:31]
    v_mfma_f32_32x32x16_bf16 v[48:63], v[88:91], v[188:191], v[48:63]
    v_mfma_f32_32x32x16_bf16 v[32:47], v[92:95], v[184:187], v[32:47]
    v_mfma_f32_32x32x16_bf16 v[64:79], v[92:95], v[188:191], v[64:79]
    ds_read_b128 v[96:99], v8 offset:0
    ds_read_b128 v[100:103], v8 offset:32
    ds_read_b128 v[104:107], v8 offset:64
    ds_read_b128 v[108:111], v8 offset:96
    ds_read_b128 v[112:115], v8 offset:128
    ds_read_b128 v[116:119], v8 offset:160
    ds_read_b128 v[120:123], v8 offset:192
    ds_read_b128 v[124:127], v8 offset:224
    s_waitcnt vmcnt(0)
    s_mov_b32 s61, 0x3acccccd
    s_mov_b32 s62, 0x3727c5ac
    s_mov_b32 s63, 0x3ea52b5c
    v_mov_b32 v11, s63
    v_cmp_gt_u32 vcc, 32, v0
    s_nop 1
    v_cndmask_b32 v11, v11, 1.0, vcc
    v_add_f32 v208, v208, v210
    v_add_f32 v209, v209, v211
    v_add_f32 v212, v212, v214
    v_add_f32 v213, v213, v215
    v_add_f32 v208, v208, v212
    v_add_f32 v209, v209, v213
    v_mov_b32 v210, v208
    s_nop 1
    v_permlane32_swap_b32 v208, v210
    v_add_f32 v208, v208, v210
    v_mov_b32 v210, v209
    s_nop 1
    v_permlane32_swap_b32 v209, v210
    v_add_f32 v209, v209, v210
    v_mul_f32 v208, s61, v208
    v_mul_f32 v209, s61, v209
    v_fma_f32 v209, -v208, v208, v209
    v_max_f32 v209, 0, v209
    v_add_f32 v209, s62, v209
    v_rsq_f32 v226, v209
    v_sub_f32 v224, 0, v208
    v_mul_f32 v228, s63, v226
    v_mul_f32 v230, v11, v226
    v_add_f32 v216, v216, v218
    v_add_f32 v217, v217, v219
    v_add_f32 v220, v220, v222
    v_add_f32 v221, v221, v223
    v_add_f32 v216, v216, v220
    v_add_f32 v217, v217, v221
    v_mov_b32 v218, v216
    s_nop 1
    v_permlane32_swap_b32 v216, v218
    v_add_f32 v216, v216, v218
    v_mov_b32 v218, v217
    s_nop 1
    v_permlane32_swap_b32 v217, v218
    v_add_f32 v217, v217, v218
    v_mul_f32 v216, s61, v216
    v_mul_f32 v217, s61, v217
    v_fma_f32 v217, -v216, v216, v217
    v_max_f32 v217, 0, v217
    v_add_f32 v217, s62, v217
    v_rsq_f32 v234, v217
    v_sub_f32 v232, 0, v216
    v_mul_f32 v236, s63, v234
    v_mul_f32 v238, v11, v234
    s_waitcnt lgkmcnt(0)
    v_pk_fma_f32 v[16:17], v[96:97], v[224:225], v[16:17] op_sel_hi:[1,0,1]
    v_pk_fma_f32 v[18:19], v[98:99], v[224:225], v[18:19] op_sel_hi:[1,0,1]
    v_pk_mul_f32 v[16:17], v[16:17], v[226:227] op_sel_hi:[1,0]
    v_pk_mul_f32 v[18:19], v[18:19], v[226:227] op_sel_hi:[1,0]
    v_cvt_pk_bf16_f32 v128, v16, v17
    v_cvt_pk_bf16_f32 v129, v18, v19
    v_pk_fma_f32 v[20:21], v[100:101], v[224:225], v[20:21] op_sel_hi:[1,0,1]
    v_pk_fma_f32 v[22:23], v[102:103], v[224:225], v[22:23] op_sel_hi:[1,0,1]
    v_pk_mul_f32 v[20:21], v[20:21], v[226:227] op_sel_hi:[1,0]
    v_pk_mul_f32 v[22:23], v[22:23], v[226:227] op_sel_hi:[1,0]
    v_cvt_pk_bf16_f32 v130, v20, v21
    v_cvt_pk_bf16_f32 v131, v22, v23
    v_pk_fma_f32 v[24:25], v[104:105], v[224:225], v[24:25] op_sel_hi:[1,0,1]
    v_pk_fma_f32 v[26:27], v[106:107], v[224:225], v[26:27] op_sel_hi:[1,0,1]
    v_pk_mul_f32 v[24:25], v[24:25], v[230:231] op_sel_hi:[1,0]
    v_pk_mul_f32 v[26:27], v[26:27], v[230:231] op_sel_hi:[1,0]
    v_cvt_pk_bf16_f32 v176, v24, v25
    v_cvt_pk_bf16_f32 v177, v26, v27
    v_pk_fma_f32 v[28:29], v[108:109], v[224:225], v[28:29] op_sel_hi:[1,0,1]
    v_pk_fma_f32 v[30:31], v[110:111], v[224:225], v[30:31] op_sel_hi:[1,0,1]
    v_pk_mul_f32 v[28:29], v[28:29], v[226:227] op_sel_hi:[1,0]
    v_pk_mul_f32 v[30:31], v[30:31], v[226:227] op_sel_hi:[1,0]
    v_cvt_pk_bf16_f32 v136, v28, v29
    v_cvt_pk_bf16_f32 v137, v30, v31
    v_pk_fma_f32 v[32:33], v[112:113], v[224:225], v[32:33] op_sel_hi:[1,0,1]
    v_pk_fma_f32 v[34:35], v[114:115], v[224:225], v[34:35] op_sel_hi:[1,0,1]
    v_pk_mul_f32 v[32:33], v[32:33], v[228:229] op_sel_hi:[1,0]
    v_pk_mul_f32 v[34:35], v[34:35], v[228:229] op_sel_hi:[1,0]
    v_cvt_pk_bf16_f32 v168, v32, v33
    v_cvt_pk_bf16_f32 v169, v34, v35
    v_pk_fma_f32 v[36:37], v[116:117], v[224:225], v[36:37] op_sel_hi:[1,0,1]
    v_pk_fma_f32 v[38:39], v[118:119], v[224:225], v[38:39] op_sel_hi:[1,0,1]
    v_pk_mul_f32 v[36:37], v[36:37], v[228:229] op_sel_hi:[1,0]
    v_pk_mul_f32 v[38:39], v[38:39], v[228:229] op_sel_hi:[1,0]
    v_cvt_pk_bf16_f32 v170, v36, v37
    v_cvt_pk_bf16_f32 v171, v38, v39
    v_pk_fma_f32 v[40:41], v[120:121], v[224:225], v[40:41] op_sel_hi:[1,0,1]
    v_pk_fma_f32 v[42:43], v[122:123], v[224:225], v[42:43] op_sel_hi:[1,0,1]
    v_pk_mul_f32 v[40:41], v[40:41], v[226:227] op_sel_hi:[1,0]
    v_pk_mul_f32 v[42:43], v[42:43], v[226:227] op_sel_hi:[1,0]
    v_cvt_pk_bf16_f32 v138, v40, v41
    v_cvt_pk_bf16_f32 v139, v42, v43
    v_pk_fma_f32 v[44:45], v[124:125], v[224:225], v[44:45] op_sel_hi:[1,0,1]
    v_pk_fma_f32 v[46:47], v[126:127], v[224:225], v[46:47] op_sel_hi:[1,0,1]
    v_pk_mul_f32 v[44:45], v[44:45], v[226:227] op_sel_hi:[1,0]
    v_pk_mul_f32 v[46:47], v[46:47], v[226:227] op_sel_hi:[1,0]
    v_cvt_pk_bf16_f32 v140, v44, v45
    v_cvt_pk_bf16_f32 v141, v46, v47
    v_mov_b32 v12, 0x3f803f80
    v_cndmask_b32 v140, v12, v140, vcc
    v_cndmask_b32 v141, v12, v141, vcc
    v_pk_fma_f32 v[48:49], v[96:97], v[232:233], v[48:49] op_sel_hi:[1,0,1]
    v_pk_fma_f32 v[50:51], v[98:99], v[232:233], v[50:51] op_sel_hi:[1,0,1]
    v_pk_mul_f32 v[48:49], v[48:49], v[234:235] op_sel_hi:[1,0]
    v_pk_mul_f32 v[50:51], v[50:51], v[234:235] op_sel_hi:[1,0]
    v_cvt_pk_bf16_f32 v132, v48, v49
    v_cvt_pk_bf16_f32 v133, v50, v51
    v_pk_fma_f32 v[52:53], v[100:101], v[232:233], v[52:53] op_sel_hi:[1,0,1]
    v_pk_fma_f32 v[54:55], v[102:103], v[232:233], v[54:55] op_sel_hi:[1,0,1]
    v_pk_mul_f32 v[52:53], v[52:53], v[234:235] op_sel_hi:[1,0]
    v_pk_mul_f32 v[54:55], v[54:55], v[234:235] op_sel_hi:[1,0]
    v_cvt_pk_bf16_f32 v134, v52, v53
    v_cvt_pk_bf16_f32 v135, v54, v55
    v_pk_fma_f32 v[56:57], v[104:105], v[232:233], v[56:57] op_sel_hi:[1,0,1]
    v_pk_fma_f32 v[58:59], v[106:107], v[232:233], v[58:59] op_sel_hi:[1,0,1]
    v_pk_mul_f32 v[56:57], v[56:57], v[238:239] op_sel_hi:[1,0]
    v_pk_mul_f32 v[58:59], v[58:59], v[238:239] op_sel_hi:[1,0]
    v_cvt_pk_bf16_f32 v178, v56, v57
    v_cvt_pk_bf16_f32 v179, v58, v59
    v_pk_fma_f32 v[60:61], v[108:109], v[232:233], v[60:61] op_sel_hi:[1,0,1]
    v_pk_fma_f32 v[62:63], v[110:111], v[232:233], v[62:63] op_sel_hi:[1,0,1]
    v_pk_mul_f32 v[60:61], v[60:61], v[234:235] op_sel_hi:[1,0]
    v_pk_mul_f32 v[62:63], v[62:63], v[234:235] op_sel_hi:[1,0]
    v_cvt_pk_bf16_f32 v142, v60, v61
    v_cvt_pk_bf16_f32 v143, v62, v63
    v_pk_fma_f32 v[64:65], v[112:113], v[232:233], v[64:65] op_sel_hi:[1,0,1]
    v_pk_fma_f32 v[66:67], v[114:115], v[232:233], v[66:67] op_sel_hi:[1,0,1]
    v_pk_mul_f32 v[64:65], v[64:65], v[236:237] op_sel_hi:[1,0]
    v_pk_mul_f32 v[66:67], v[66:67], v[236:237] op_sel_hi:[1,0]
    v_cvt_pk_bf16_f32 v172, v64, v65
    v_cvt_pk_bf16_f32 v173, v66, v67
    v_pk_fma_f32 v[68:69], v[116:117], v[232:233], v[68:69] op_sel_hi:[1,0,1]
    v_pk_fma_f32 v[70:71], v[118:119], v[232:233], v[70:71] op_sel_hi:[1,0,1]
    v_pk_mul_f32 v[68:69], v[68:69], v[236:237] op_sel_hi:[1,0]
    v_pk_mul_f32 v[70:71], v[70:71], v[236:237] op_sel_hi:[1,0]
    v_cvt_pk_bf16_f32 v174, v68, v69
    v_cvt_pk_bf16_f32 v175, v70, v71
    v_pk_fma_f32 v[72:73], v[120:121], v[232:233], v[72:73] op_sel_hi:[1,0,1]
    v_pk_fma_f32 v[74:75], v[122:123], v[232:233], v[74:75] op_sel_hi:[1,0,1]
    v_pk_mul_f32 v[72:73], v[72:73], v[234:235] op_sel_hi:[1,0]
    v_pk_mul_f32 v[74:75], v[74:75], v[234:235] op_sel_hi:[1,0]
    v_cvt_pk_bf16_f32 v144, v72, v73
    v_cvt_pk_bf16_f32 v145, v74, v75
    v_pk_fma_f32 v[76:77], v[124:125], v[232:233], v[76:77] op_sel_hi:[1,0,1]
    v_pk_fma_f32 v[78:79], v[126:127], v[232:233], v[78:79] op_sel_hi:[1,0,1]
    v_pk_mul_f32 v[76:77], v[76:77], v[234:235] op_sel_hi:[1,0]
    v_pk_mul_f32 v[78:79], v[78:79], v[234:235] op_sel_hi:[1,0]
    v_cvt_pk_bf16_f32 v146, v76, v77
    v_cvt_pk_bf16_f32 v147, v78, v79
    v_mov_b32 v12, 0x3f803f80
    v_cndmask_b32 v146, v12, v146, vcc
    v_cndmask_b32 v147, v12, v147, vcc
    s_mul_i32 s80, s53, 6291456
    s_mul_i32 s61, s55, 172032
    s_add_u32 s80, s80, s61
    s_add_u32 s80, s80, 1048576
    s_mul_i32 s61, s54, 21504
    s_add_u32 s61, s61, s80
    s_mul_i32 s62, s52, 3072
    s_add_u32 s62, s62, 145408
    v_and_b32 v2, 31, v0
    v_lshrrev_b32 v3, 5, v0
    v_mul_u32_u24 v4, 48, v2
    v_lshl_add_u32 v4, v3, 3, v4
    v_add_u32 v4, s62, v4
    ds_write_b64 v4, v[136:137] offset:0
    ds_write_b64 v4, v[138:139] offset:16
    ds_write_b64 v4, v[140:141] offset:32
    ds_write_b64 v4, v[142:143] offset:1536
    ds_write_b64 v4, v[144:145] offset:1552
    ds_write_b64 v4, v[146:147] offset:1568
    s_lshl_b32 s63, s52, 11
    v_lshlrev_b32 v5, 4, v0
    v_add_u32 v5, s63, v5
    v_add_u32 v6, 102400, v5
    v_bfe_u32 v7, v0, 2, 2
    v_lshl_add_u32 v7, v3, 2, v7
    v_mul_u32_u24 v7, 48, v7
    v_and_b32 v8, 16, v0
    v_lshl_add_u32 v7, v8, 1, v7
    v_and_b32 v8, 3, v0
    v_lshl_add_u32 v7, v8, 3, v7
    v_add_u32 v7, s62, v7
    buffer_store_dwordx4 v[128:131], v5, s[40:43], s61 offen offset:0 sc1
    ds_write_b128 v6, v[128:131] offset:0
    buffer_store_dwordx4 v[132:135], v5, s[40:43], s61 offen offset:1024 sc1
    ds_write_b128 v6, v[132:135] offset:1024
    s_lshl_b32 s63, s52, 9
    s_add_u32 s63, s63, 8192
    v_lshlrev_b32 v5, 4, v0
    v_add_u32 v5, s63, v5
    v_add_u32 v6, 102400, v5
    s_mov_b32 s70, -1
    s_mov_b32 s71, 0
    s_mov_b64 exec, s[70:71]
    buffer_store_dwordx4 v[176:179], v5, s[40:43], s61 offen sc1
    ds_write_b128 v6, v[176:179]
    s_mov_b64 exec, -1
    s_waitcnt lgkmcnt(0)
    ds_read_b64_tr_b16 v[144:145], v7 offset:0
    ds_read_b64_tr_b16 v[146:147], v7 offset:384
    ds_read_b64_tr_b16 v[148:149], v7 offset:768
    ds_read_b64_tr_b16 v[150:151], v7 offset:1152
    ds_read_b64_tr_b16 v[152:153], v7 offset:1536
    ds_read_b64_tr_b16 v[154:155], v7 offset:1920
    ds_read_b64_tr_b16 v[156:157], v7 offset:2304
    ds_read_b64_tr_b16 v[158:159], v7 offset:2688
    v_permlane32_swap_b32 v176, v178
    v_permlane32_swap_b32 v177, v179
    s_mul_i32 s63, s52, 2688
    s_add_u32 s63, s63, 10240
    v_mul_u32_u24 v5, 336, v3
    v_lshl_add_u32 v5, v2, 4, v5
    v_add_u32 v5, s63, v5
    v_add_u32 v6, 102400, v5
    s_mov_b32 s70, 0x1fffff
    s_mov_b32 s71, 0x1fffff
    s_waitcnt lgkmcnt(0)
    s_mov_b64 exec, s[70:71]
    buffer_store_dwordx4 v[144:147], v5, s[40:43], s61 offen offset:0 sc1
    ds_write_b128 v6, v[144:147] offset:0
    buffer_store_dwordx4 v[148:151], v5, s[40:43], s61 offen offset:672 sc1
    ds_write_b128 v6, v[148:151] offset:672
    buffer_store_dwordx4 v[152:155], v5, s[40:43], s61 offen offset:1344 sc1
    ds_write_b128 v6, v[152:155] offset:1344
    buffer_store_dwordx4 v[156:159], v5, s[40:43], s61 offen offset:2016 sc1
    ds_write_b128 v6, v[156:159] offset:2016
    s_mov_b64 exec, -1
    s_waitcnt lgkmcnt(0)
    s_lshl_b32 s61, s54, 2
    s_add_u32 s61, s61, s52
    s_lshl_b32 s62, s61, 10
    v_lshlrev_b32 v10, 4, v0
    v_add_u32 v11, s62, v10
    ds_read_b128 v[208:211], v11
    ds_read_b128 v[212:215], v11 offset:32768
    v_add_u32 v11, 65536, v11
    ds_read_b128 v[216:219], v11
    s_waitcnt lgkmcnt(0)
    s_barrier
    v_lshlrev_b32 v193, 4, v0
    v_add_u32 v180, 102400, v193
    v_and_b32 v2, 31, v0
    v_lshlrev_b32 v181, 4, v2
    v_add_u32 v181, 110592, v181
    v_min_u32 v2, 20, v2
    v_lshrrev_b32 v3, 5, v0
    v_mul_u32_u24 v3, 336, v3
    v_lshl_add_u32 v182, v2, 4, v3
    v_add_u32 v182, 112640, v182
    v_add_u32 v183, 21504, v180
    v_add_u32 v184, 21504, v181
    v_add_u32 v185, 21504, v182
    ds_read_b128 v[128:131], v180 offset:0
    ds_read_b128 v[132:135], v180 offset:1024
    ds_read_b128 v[136:139], v181 offset:0
    ds_read_b128 v[144:147], v182 offset:0
    ds_read_b128 v[148:151], v182 offset:672
    v_add_u32 v2, 0, v0
    v_mul_u32_u24 v3, 6554, v2
    v_lshrrev_b32 v3, 16, v3
    v_lshlrev_b32 v2, 4, v2
    v_mul_u32_u24 v3, 1120, v3
    v_add_u32 v188, v2, v3
    v_add_u32 v2, 64, v0
    v_mul_u32_u24 v3, 6554, v2
    v_lshrrev_b32 v3, 16, v3
    v_lshlrev_b32 v2, 4, v2
    v_mul_u32_u24 v3, 1120, v3
    v_add_u32 v189, v2, v3
    v_subrev_u32 v189, 1024, v189
    v_add_u32 v2, 128, v0
    v_mul_u32_u24 v3, 6554, v2
    v_lshrrev_b32 v3, 16, v3
    v_lshlrev_b32 v2, 4, v2
    v_mul_u32_u24 v3, 1120, v3
    v_add_u32 v190, v2, v3
    v_subrev_u32 v190, 2048, v190
    v_add_u32 v2, 192, v0
    v_mul_u32_u24 v3, 6554, v2
    v_lshrrev_b32 v3, 16, v3
    v_lshlrev_b32 v2, 4, v2
    v_mul_u32_u24 v3, 1120, v3
    v_add_u32 v191, v2, v3
    v_subrev_u32 v191, 3072, v191
    v_add_u32 v2, 256, v0
    v_mul_u32_u24 v3, 6554, v2
    v_lshrrev_b32 v3, 16, v3
    v_lshlrev_b32 v2, 4, v2
    v_mul_u32_u24 v3, 1120, v3
    v_add_u32 v192, v2, v3
    s_mov_b32 s85, 0
    s_mov_b32 s86, 102400
    s_mov_b32 s87, 123904
    s_mul_i32 s93, s52, 5376
    s_add_u32 s92, s80, s93
    s_mul_i32 s94, s57, 160
    s_mul_i32 s61, s52, 204800
    s_add_u32 s94, s94, s61
    s_mov_b32 s76, s94
    s_add_u32 s88, s54, 1
    s_and_b32 s88, s88, 7
    s_waitcnt lgkmcnt(0)
    v_mfma_f32_32x32x4_2b_bf16 v[16:47], v[136:137], v[178:179], 0
    s_mul_i32 s96, s52, 25600
    s_mov_b32 s75, s96
    s_lshl_b32 s97, s53, 16
    s_add_u32 s97, s97, 36659200
    s_lshl_b32 s68, s55, 7
    s_add_u32 s97, s97, s68
    s_lshl_b32 s67, s53, 16
    s_add_u32 s67, s67, 36659200
    s_lshl_b32 s68, s55, 7
    s_add_u32 s67, s67, s68
    s_lshl_b32 s68, s54, 4
    s_add_u32 s67, s67, s68
    s_lshl_b32 s68, s52, 2
    s_add_u32 s67, s67, s68
    v_and_b32 v204, 31, v0
    v_lshlrev_b32 v204, 2, v204
    s_nop 2
    v_mfma_f32_32x32x16_bf16 v[16:31], v[128:131], v[168:171], v[16:31]
    v_mfma_f32_32x32x16_bf16 v[32:47], v[128:131], v[172:175], v[32:47]
    v_mov_b32 v96, 0
    v_mov_b32 v97, 0
    v_mov_b32 v98, 0
    v_mov_b32 v99, 0
    v_mov_b32 v100, 0
    v_mov_b32 v101, 0
    v_mov_b32 v102, 0
    v_mov_b32 v103, 0
    v_mov_b32 v104, 0
    v_mov_b32 v105, 0
    v_mov_b32 v106, 0
    v_mov_b32 v107, 0
    v_mov_b32 v108, 0
    v_mov_b32 v109, 0
    v_mov_b32 v110, 0
    v_mov_b32 v111, 0
    s_and_b32 s61, s57, 3
    s_lshl_b32 s61, s61, 2
    s_add_u32 s61, s61, s52
    s_mul_i32 s61, s61, 393216
    s_lshl_b32 s77, s56, 7
    s_add_u32 s77, s77, s61
    v_lshlrev_b32 v201, 12, v0
    v_add_u32 v201, s77, v201
    s_xor_b32 s98, s53, 1
    s_and_b32 s98, s98, s60
    s_mul_i32 s61, s58, 13
    s_lshr_b32 s61, s61, 6
    s_mul_i32 s61, s61, 5
    s_sub_u32 s61, s58, s61
    s_lshl_b32 s61, s61, 2
    s_add_u32 s61, s61, s52
    s_mul_i32 s61, s61, 104
    s_lshl_b32 s62, s59, 7
    v_add_u32 v200, s61, v0
    v_mul_u32_u24 v200, 3072, v200
    v_add_u32 v200, s62, v200
    s_mov_b32 s44, s16
    s_mov_b32 s45, s17
    s_mov_b32 s46, s18
    s_mov_b32 s47, s19
    s_mov_b32 s95, 2
    s_cmp_lg_u32 s98, 0
    s_cbranch_scc1 L_pfw1
    v_mov_b32 v200, v201
    s_mov_b32 s44, s20
    s_mov_b32 s45, s21
    s_mov_b32 s95, 7
L_pfw1:
    v_mfma_f32_32x32x4_2b_bf16 v[48:79], v[138:139], v[178:179], 0
    v_exp_f32 v16, v16
    v_exp_f32 v17, v17
    ds_read_b128 v[128:131], v180 offset:2048
    v_exp_f32 v18, v18
    v_exp_f32 v19, v19
    v_cvt_pk_bf16_f32 v112, v16, v17
    ds_read_b128 v[140:143], v181 offset:512
    v_exp_f32 v20, v20
    v_exp_f32 v21, v21
    v_cvt_pk_bf16_f32 v113, v18, v19
    v_exp_f32 v22, v22
    v_exp_f32 v23, v23
    v_cvt_pk_bf16_f32 v114, v20, v21
    v_exp_f32 v24, v24
    v_exp_f32 v25, v25
    v_cvt_pk_bf16_f32 v115, v22, v23
    v_exp_f32 v26, v26
    v_exp_f32 v27, v27
    ds_read_b128 v[152:155], v182 offset:1344
    v_cvt_pk_bf16_f32 v116, v24, v25
    v_exp_f32 v28, v28
    v_exp_f32 v29, v29
    ds_read_b128 v[156:159], v182 offset:2016
    v_cvt_pk_bf16_f32 v117, v26, v27
    v_exp_f32 v30, v30
    v_mfma_f32_32x32x16_bf16 v[48:63], v[132:135], v[168:171], v[48:63]
    v_exp_f32 v31, v31
    v_cvt_pk_bf16_f32 v118, v28, v29
    v_exp_f32 v32, v32
    v_cvt_pk_bf16_f32 v119, v30, v31
    v_exp_f32 v33, v33
    v_exp_f32 v34, v34
    v_mfma_f32_32x32x16_bf16 v[80:95], v[144:147], v[112:115], 0
    v_exp_f32 v35, v35
    v_cvt_pk_bf16_f32 v120, v32, v33
    v_exp_f32 v36, v36
    v_exp_f32 v37, v37
    v_cvt_pk_bf16_f32 v121, v34, v35
    v_exp_f32 v38, v38
    v_exp_f32 v39, v39
    v_mfma_f32_32x32x16_bf16 v[64:79], v[132:135], v[172:175], v[64:79]
    v_cvt_pk_bf16_f32 v122, v36, v37
    v_exp_f32 v40, v40
    v_exp_f32 v41, v41
    v_cvt_pk_bf16_f32 v123, v38, v39
    v_exp_f32 v42, v42
    v_exp_f32 v43, v43
    v_mfma_f32_32x32x16_bf16 v[80:95], v[148:151], v[116:119], v[80:95]
    v_cvt_pk_bf16_f32 v124, v40, v41
    v_exp_f32 v44, v44
    v_exp_f32 v45, v45
    v_cvt_pk_bf16_f32 v125, v42, v43
    v_exp_f32 v46, v46
    v_exp_f32 v47, v47
    v_cvt_pk_bf16_f32 v126, v44, v45
    s_waitcnt lgkmcnt(0)
    v_cvt_pk_bf16_f32 v127, v46, v47
    v_mfma_f32_32x32x4_2b_bf16 v[16:47], v[140:141], v[178:179], 0
    v_exp_f32 v48, v48
    v_exp_f32 v49, v49
    ds_read_b128 v[132:135], v180 offset:3072
    v_exp_f32 v50, v50
    v_exp_f32 v51, v51
    v_cvt_pk_bf16_f32 v112, v48, v49
    v_exp_f32 v52, v52
    v_exp_f32 v53, v53
    v_cvt_pk_bf16_f32 v113, v50, v51
    v_mfma_f32_32x32x16_bf16 v[96:111], v[144:147], v[120:123], v[96:111]
    v_exp_f32 v54, v54
    v_exp_f32 v55, v55
    v_cvt_pk_bf16_f32 v114, v52, v53
    v_exp_f32 v56, v56
    v_exp_f32 v57, v57
    v_cvt_pk_bf16_f32 v115, v54, v55
    v_mfma_f32_32x32x16_bf16 v[96:111], v[148:151], v[124:127], v[96:111]
    v_exp_f32 v58, v58
    v_exp_f32 v59, v59
    ds_read_b128 v[144:147], v182 offset:2688
    v_cvt_pk_bf16_f32 v116, v56, v57
    v_exp_f32 v60, v60
    v_exp_f32 v61, v61
    ds_read_b128 v[148:151], v182 offset:3360
    v_cvt_pk_bf16_f32 v117, v58, v59
    v_exp_f32 v62, v62
    v_mfma_f32_32x32x16_bf16 v[16:31], v[128:131], v[168:171], v[16:31]
    v_exp_f32 v63, v63
    v_cvt_pk_bf16_f32 v118, v60, v61
    v_exp_f32 v64, v64
    v_cvt_pk_bf16_f32 v119, v62, v63
    v_exp_f32 v65, v65
    v_exp_f32 v66, v66
    v_mfma_f32_32x32x16_bf16 v[80:95], v[152:155], v[112:115], v[80:95]
    v_exp_f32 v67, v67
    v_cvt_pk_bf16_f32 v120, v64, v65
    v_exp_f32 v68, v68
    v_exp_f32 v69, v69
    v_cvt_pk_bf16_f32 v121, v66, v67
    v_exp_f32 v70, v70
    v_exp_f32 v71, v71
    v_mfma_f32_32x32x16_bf16 v[32:47], v[128:131], v[172:175], v[32:47]
    v_cvt_pk_bf16_f32 v122, v68, v69
    v_exp_f32 v72, v72
    v_exp_f32 v73, v73
    v_cvt_pk_bf16_f32 v123, v70, v71
    v_exp_f32 v74, v74
    v_exp_f32 v75, v75
    v_mfma_f32_32x32x16_bf16 v[80:95], v[156:159], v[116:119], v[80:95]
    v_cvt_pk_bf16_f32 v124, v72, v73
    v_exp_f32 v76, v76
    v_exp_f32 v77, v77
    v_cvt_pk_bf16_f32 v125, v74, v75
    v_exp_f32 v78, v78
    v_exp_f32 v79, v79
    v_cvt_pk_bf16_f32 v126, v76, v77
    s_waitcnt lgkmcnt(0)
    v_cvt_pk_bf16_f32 v127, v78, v79
    s_waitcnt vmcnt(0)
    s_mov_b64 exec, 1
    buffer_atomic_swap v243, off, s[40:43], s67 sc1
    s_mov_b64 exec, -1
    v_mfma_f32_32x32x4_2b_bf16 v[48:79], v[142:143], v[178:179], 0
    v_exp_f32 v16, v16
    v_exp_f32 v17, v17
    ds_read_b128 v[128:131], v180 offset:4096
    v_exp_f32 v18, v18
    v_exp_f32 v19, v19
    v_cvt_pk_bf16_f32 v112, v16, v17
    ds_read_b128 v[136:139], v181 offset:1024
    v_exp_f32 v20, v20
    v_exp_f32 v21, v21
    v_cvt_pk_bf16_f32 v113, v18, v19
    v_mfma_f32_32x32x16_bf16 v[96:111], v[152:155], v[120:123], v[96:111]
    v_exp_f32 v22, v22
    v_exp_f32 v23, v23
    v_cvt_pk_bf16_f32 v114, v20, v21
    v_exp_f32 v24, v24
    v_exp_f32 v25, v25
    v_cvt_pk_bf16_f32 v115, v22, v23
    v_mfma_f32_32x32x16_bf16 v[96:111], v[156:159], v[124:127], v[96:111]
    v_exp_f32 v26, v26
    v_exp_f32 v27, v27
    ds_read_b128 v[152:155], v182 offset:4032
    v_cvt_pk_bf16_f32 v116, v24, v25
    v_exp_f32 v28, v28
    v_exp_f32 v29, v29
    ds_read_b128 v[156:159], v182 offset:4704
    v_cvt_pk_bf16_f32 v117, v26, v27
    v_exp_f32 v30, v30
    v_mfma_f32_32x32x16_bf16 v[48:63], v[132:135], v[168:171], v[48:63]
    v_exp_f32 v31, v31
    v_cvt_pk_bf16_f32 v118, v28, v29
    v_exp_f32 v32, v32
    v_cvt_pk_bf16_f32 v119, v30, v31
    v_exp_f32 v33, v33
    v_exp_f32 v34, v34
    v_mfma_f32_32x32x16_bf16 v[80:95], v[144:147], v[112:115], v[80:95]
    v_exp_f32 v35, v35
    v_cvt_pk_bf16_f32 v120, v32, v33
    v_exp_f32 v36, v36
    v_exp_f32 v37, v37
    v_cvt_pk_bf16_f32 v121, v34, v35
    v_exp_f32 v38, v38
    v_exp_f32 v39, v39
    v_mfma_f32_32x32x16_bf16 v[64:79], v[132:135], v[172:175], v[64:79]
    v_cvt_pk_bf16_f32 v122, v36, v37
    v_exp_f32 v40, v40
    v_exp_f32 v41, v41
    v_cvt_pk_bf16_f32 v123, v38, v39
    v_exp_f32 v42, v42
    v_exp_f32 v43, v43
    v_mfma_f32_32x32x16_bf16 v[80:95], v[148:151], v[116:119], v[80:95]
    v_cvt_pk_bf16_f32 v124, v40, v41
    v_exp_f32 v44, v44
    v_exp_f32 v45, v45
    v_cvt_pk_bf16_f32 v125, v42, v43
    v_exp_f32 v46, v46
    v_exp_f32 v47, v47
    v_cvt_pk_bf16_f32 v126, v44, v45
    s_waitcnt lgkmcnt(0)
    v_cvt_pk_bf16_f32 v127, v46, v47
    v_mfma_f32_32x32x4_2b_bf16 v[16:47], v[136:137], v[178:179], 0
    v_exp_f32 v48, v48
    v_exp_f32 v49, v49
    ds_read_b128 v[132:135], v180 offset:5120
    v_exp_f32 v50, v50
    v_exp_f32 v51, v51
    v_cvt_pk_bf16_f32 v112, v48, v49
    v_exp_f32 v52, v52
    v_exp_f32 v53, v53
    v_cvt_pk_bf16_f32 v113, v50, v51
    v_mfma_f32_32x32x16_bf16 v[96:111], v[144:147], v[120:123], v[96:111]
    v_exp_f32 v54, v54
    v_exp_f32 v55, v55
    v_cvt_pk_bf16_f32 v114, v52, v53
    v_exp_f32 v56, v56
    v_exp_f32 v57, v57
    v_cvt_pk_bf16_f32 v115, v54, v55
    v_mfma_f32_32x32x16_bf16 v[96:111], v[148:151], v[124:127], v[96:111]
    v_exp_f32 v58, v58
    v_exp_f32 v59, v59
    ds_read_b128 v[144:147], v182 offset:5376
    v_cvt_pk_bf16_f32 v116, v56, v57
    v_exp_f32 v60, v60
    v_exp_f32 v61, v61
    ds_read_b128 v[148:151], v182 offset:6048
    v_cvt_pk_bf16_f32 v117, v58, v59
    v_exp_f32 v62, v62
    v_mfma_f32_32x32x16_bf16 v[16:31], v[128:131], v[168:171], v[16:31]
    v_exp_f32 v63, v63
    v_cvt_pk_bf16_f32 v118, v60, v61
    v_exp_f32 v64, v64
    v_cvt_pk_bf16_f32 v119, v62, v63
    v_exp_f32 v65, v65
    v_exp_f32 v66, v66
    v_mfma_f32_32x32x16_bf16 v[80:95], v[152:155], v[112:115], v[80:95]
    v_exp_f32 v67, v67
    v_cvt_pk_bf16_f32 v120, v64, v65
    v_exp_f32 v68, v68
    v_exp_f32 v69, v69
    v_cvt_pk_bf16_f32 v121, v66, v67
    v_exp_f32 v70, v70
    v_exp_f32 v71, v71
    v_mfma_f32_32x32x16_bf16 v[32:47], v[128:131], v[172:175], v[32:47]
    v_cvt_pk_bf16_f32 v122, v68, v69
    v_exp_f32 v72, v72
    v_exp_f32 v73, v73
    v_cvt_pk_bf16_f32 v123, v70, v71
    v_exp_f32 v74, v74
    v_exp_f32 v75, v75
    v_mfma_f32_32x32x16_bf16 v[80:95], v[156:159], v[116:119], v[80:95]
    v_cvt_pk_bf16_f32 v124, v72, v73
    v_exp_f32 v76, v76
    v_exp_f32 v77, v77
    v_cvt_pk_bf16_f32 v125, v74, v75
    v_exp_f32 v78, v78
    v_exp_f32 v79, v79
    v_cvt_pk_bf16_f32 v126, v76, v77
    s_waitcnt lgkmcnt(0)
    v_cvt_pk_bf16_f32 v127, v78, v79
    buffer_load_dword v1, v204, s[40:43], s97 offen sc1
    v_mfma_f32_32x32x4_2b_bf16 v[48:79], v[138:139], v[178:179], 0
    v_exp_f32 v16, v16
    v_exp_f32 v17, v17
    ds_read_b128 v[128:131], v180 offset:6144
    v_exp_f32 v18, v18
    v_exp_f32 v19, v19
    v_cvt_pk_bf16_f32 v112, v16, v17
    ds_read_b128 v[140:143], v181 offset:1536
    v_exp_f32 v20, v20
    v_exp_f32 v21, v21
    v_cvt_pk_bf16_f32 v113, v18, v19
    v_mfma_f32_32x32x16_bf16 v[96:111], v[152:155], v[120:123], v[96:111]
    v_exp_f32 v22, v22
    v_exp_f32 v23, v23
    v_cvt_pk_bf16_f32 v114, v20, v21
    v_exp_f32 v24, v24
    v_exp_f32 v25, v25
    v_cvt_pk_bf16_f32 v115, v22, v23
    v_mfma_f32_32x32x16_bf16 v[96:111], v[156:159], v[124:127], v[96:111]
    v_exp_f32 v26, v26
    v_exp_f32 v27, v27
    ds_read_b128 v[152:155], v182 offset:6720
    v_cvt_pk_bf16_f32 v116, v24, v25
    v_exp_f32 v28, v28
    v_exp_f32 v29, v29
    ds_read_b128 v[156:159], v182 offset:7392
    v_cvt_pk_bf16_f32 v117, v26, v27
    v_exp_f32 v30, v30
    v_mfma_f32_32x32x16_bf16 v[48:63], v[132:135], v[168:171], v[48:63]
    v_exp_f32 v31, v31
    v_cvt_pk_bf16_f32 v118, v28, v29
    v_exp_f32 v32, v32
    v_cvt_pk_bf16_f32 v119, v30, v31
    v_exp_f32 v33, v33
    v_exp_f32 v34, v34
    v_mfma_f32_32x32x16_bf16 v[80:95], v[144:147], v[112:115], v[80:95]
    v_exp_f32 v35, v35
    v_cvt_pk_bf16_f32 v120, v32, v33
    v_exp_f32 v36, v36
    v_exp_f32 v37, v37
    v_cvt_pk_bf16_f32 v121, v34, v35
    v_exp_f32 v38, v38
    v_exp_f32 v39, v39
    v_mfma_f32_32x32x16_bf16 v[64:79], v[132:135], v[172:175], v[64:79]
    v_cvt_pk_bf16_f32 v122, v36, v37
    v_exp_f32 v40, v40
    v_exp_f32 v41, v41
    v_cvt_pk_bf16_f32 v123, v38, v39
    v_exp_f32 v42, v42
    v_exp_f32 v43, v43
    v_mfma_f32_32x32x16_bf16 v[80:95], v[148:151], v[116:119], v[80:95]
    v_cvt_pk_bf16_f32 v124, v40, v41
    v_exp_f32 v44, v44
    v_exp_f32 v45, v45
    v_cvt_pk_bf16_f32 v125, v42, v43
    v_exp_f32 v46, v46
    v_exp_f32 v47, v47
    v_cvt_pk_bf16_f32 v126, v44, v45
    s_waitcnt lgkmcnt(0)
    v_cvt_pk_bf16_f32 v127, v46, v47
    s_waitcnt vmcnt(0)
    v_cmp_ne_u32 vcc, s99, v1
    s_cbranch_vccz KVOK_12
    s_mov_b32 s82, 4194304
FW_13:
    buffer_load_dword v1, v204, s[40:43], s97 offen sc1
    s_sub_u32 s82, s82, 1
    s_cbranch_scc1 L_exit
    s_waitcnt vmcnt(0)
    v_cmp_ne_u32 vcc, s99, v1
    s_cbranch_vccnz FW_13
KVOK_12:
    s_mul_i32 s61, s88, 21504
    s_add_u32 m0, s93, s87
    s_add_u32 s61, s61, s92
    buffer_load_dwordx4 v193, s[40:43], s61 offen offset:0 lds
    buffer_load_dwordx4 v193, s[40:43], s61 offen offset:1024 lds
    buffer_load_dwordx4 v193, s[40:43], s61 offen offset:2048 lds
    buffer_load_dwordx4 v193, s[40:43], s61 offen offset:3072 lds
    s_add_u32 m0, m0, 3328
    s_add_u32 s61, s61, 3328
    buffer_load_dwordx4 v193, s[40:43], s61 offen offset:0 lds
    buffer_load_dwordx4 v193, s[40:43], s61 offen offset:1024 lds
    v_mfma_f32_32x32x4_2b_bf16 v[16:47], v[140:141], v[178:179], 0
    v_exp_f32 v48, v48
    v_exp_f32 v49, v49
    ds_read_b128 v[132:135], v180 offset:7168
    v_exp_f32 v50, v50
    v_exp_f32 v51, v51
    v_cvt_pk_bf16_f32 v112, v48, v49
    v_exp_f32 v52, v52
    v_exp_f32 v53, v53
    v_cvt_pk_bf16_f32 v113, v50, v51
    v_mfma_f32_32x32x16_bf16 v[96:111], v[144:147], v[120:123], v[96:111]
    v_exp_f32 v54, v54
    v_exp_f32 v55, v55
    v_cvt_pk_bf16_f32 v114, v52, v53
    v_exp_f32 v56, v56
    v_exp_f32 v57, v57
    v_cvt_pk_bf16_f32 v115, v54, v55
    v_mfma_f32_32x32x16_bf16 v[96:111], v[148:151], v[124:127], v[96:111]
    v_exp_f32 v58, v58
    v_exp_f32 v59, v59
    ds_read_b128 v[144:147], v182 offset:8064
    v_cvt_pk_bf16_f32 v116, v56, v57
    v_exp_f32 v60, v60
    v_exp_f32 v61, v61
    ds_read_b128 v[148:151], v182 offset:8736
    v_cvt_pk_bf16_f32 v117, v58, v59
    v_exp_f32 v62, v62
    v_mfma_f32_32x32x16_bf16 v[16:31], v[128:131], v[168:171], v[16:31]
    v_exp_f32 v63, v63
    v_cvt_pk_bf16_f32 v118, v60, v61
    ds_read_b128 v[160:163], v182 offset:9408
    v_exp_f32 v64, v64
    v_cvt_pk_bf16_f32 v119, v62, v63
    v_exp_f32 v65, v65
    v_exp_f32 v66, v66
    v_mfma_f32_32x32x16_bf16 v[80:95], v[152:155], v[112:115], v[80:95]
    v_exp_f32 v67, v67
    v_cvt_pk_bf16_f32 v120, v64, v65
    ds_read_b128 v[164:167], v182 offset:10080
    v_exp_f32 v68, v68
    v_exp_f32 v69, v69
    v_cvt_pk_bf16_f32 v121, v66, v67
    v_exp_f32 v70, v70
    v_exp_f32 v71, v71
    v_mfma_f32_32x32x16_bf16 v[32:47], v[128:131], v[172:175], v[32:47]
    v_cvt_pk_bf16_f32 v122, v68, v69
    v_exp_f32 v72, v72
    v_exp_f32 v73, v73
    v_cvt_pk_bf16_f32 v123, v70, v71
    v_exp_f32 v74, v74
    v_exp_f32 v75, v75
    v_mfma_f32_32x32x16_bf16 v[80:95], v[156:159], v[116:119], v[80:95]
    v_cvt_pk_bf16_f32 v124, v72, v73
    v_exp_f32 v76, v76
    v_exp_f32 v77, v77
    v_cvt_pk_bf16_f32 v125, v74, v75
    v_exp_f32 v78, v78
    v_exp_f32 v79, v79
    v_cvt_pk_bf16_f32 v126, v76, v77
    s_waitcnt lgkmcnt(0)
    v_cvt_pk_bf16_f32 v127, v78, v79
    s_add_u32 s88, s88, 1
    s_and_b32 s88, s88, 7
    s_mul_i32 s73, s88, 21504
    s_add_u32 s73, s73, s92
    s_add_u32 s74, s73, 3328
    s_add_u32 s72, s93, s86
    s_waitcnt vmcnt(0)
    s_barrier
    s_cmp_lg_u32 s53, 0
    s_cbranch_scc1 NOPACK_14
    s_lshl_b32 s61, s54, 2
    s_add_u32 s61, s61, s52
    s_lshl_b32 s62, s61, 10
    s_mul_i32 s63, s55, 92160
    s_add_u32 s62, s62, s63
    s_add_u32 s62, s62, 33554432
    s_add_u32 s63, s62, 32768
    s_add_u32 s64, s62, 65536
    buffer_store_dwordx4 v[208:211], v193, s[40:43], s62 offen sc1
    buffer_store_dwordx4 v[212:215], v193, s[40:43], s63 offen sc1
    s_cmp_gt_u32 s61, 25
    s_cbranch_scc1 NOPACK_14
    buffer_store_dwordx4 v[216:219], v193, s[40:43], s64 offen sc1
NOPACK_14:
    v_mfma_f32_32x32x4_2b_bf16 v[48:79], v[142:143], v[178:179], 0
    v_exp_f32 v16, v16
    v_exp_f32 v17, v17
    ds_read_b128 v[128:131], v183 offset:0
    v_exp_f32 v18, v18
    v_exp_f32 v19, v19
    v_cvt_pk_bf16_f32 v112, v16, v17
    ds_read_b128 v[136:139], v184 offset:0
    v_exp_f32 v20, v20
    v_exp_f32 v21, v21
    s_add_u32 m0, s72, 0
    v_cvt_pk_bf16_f32 v113, v18, v19
    v_mfma_f32_32x32x16_bf16 v[96:111], v[152:155], v[120:123], v[96:111]
    buffer_load_dwordx4 v193, s[40:43], s73 offen offset:0 lds
    v_exp_f32 v22, v22
    v_exp_f32 v23, v23
    v_cvt_pk_bf16_f32 v114, v20, v21
    v_exp_f32 v24, v24
    v_exp_f32 v25, v25
    v_cvt_pk_bf16_f32 v115, v22, v23
    v_mfma_f32_32x32x16_bf16 v[96:111], v[156:159], v[124:127], v[96:111]
    buffer_load_dwordx4 v193, s[40:43], s73 offen offset:1024 lds
    v_exp_f32 v26, v26
    v_exp_f32 v27, v27
    v_cvt_pk_bf16_f32 v116, v24, v25
    v_exp_f32 v28, v28
    v_exp_f32 v29, v29
    v_cvt_pk_bf16_f32 v117, v26, v27
    v_exp_f32 v30, v30
    v_mfma_f32_32x32x16_bf16 v[48:63], v[132:135], v[168:171], v[48:63]
    v_exp_f32 v31, v31
    v_cvt_pk_bf16_f32 v118, v28, v29
    v_exp_f32 v32, v32
    v_cvt_pk_bf16_f32 v119, v30, v31
    v_exp_f32 v33, v33
    v_exp_f32 v34, v34
    v_mfma_f32_32x32x16_bf16 v[80:95], v[144:147], v[112:115], v[80:95]
    v_exp_f32 v35, v35
    v_cvt_pk_bf16_f32 v120, v32, v33
    v_exp_f32 v36, v36
    v_exp_f32 v37, v37
    v_cvt_pk_bf16_f32 v121, v34, v35
    v_exp_f32 v38, v38
    v_exp_f32 v39, v39
    v_mfma_f32_32x32x16_bf16 v[64:79], v[132:135], v[172:175], v[64:79]
    v_cvt_pk_bf16_f32 v122, v36, v37
    v_exp_f32 v40, v40
    v_exp_f32 v41, v41
    v_cvt_pk_bf16_f32 v123, v38, v39
    v_exp_f32 v42, v42
    v_exp_f32 v43, v43
    v_mfma_f32_32x32x16_bf16 v[80:95], v[148:151], v[116:119], v[80:95]
    v_cvt_pk_bf16_f32 v124, v40, v41
    v_exp_f32 v44, v44
    v_exp_f32 v45, v45
    v_cvt_pk_bf16_f32 v125, v42, v43
    v_exp_f32 v46, v46
    v_exp_f32 v47, v47
    v_cvt_pk_bf16_f32 v126, v44, v45
    s_waitcnt lgkmcnt(0)
    v_cvt_pk_bf16_f32 v127, v46, v47
    v_mfma_f32_32x32x4_2b_bf16 v[16:47], v[136:137], v[178:179], 0
    v_exp_f32 v48, v48
    v_exp_f32 v49, v49
    ds_read_b128 v[132:135], v183 offset:1024
    v_exp_f32 v50, v50
    v_exp_f32 v51, v51
    v_cvt_pk_bf16_f32 v112, v48, v49
    v_exp_f32 v52, v52
    v_exp_f32 v53, v53
    s_add_u32 m0, s72, 0
    v_cvt_pk_bf16_f32 v113, v50, v51
    v_mfma_f32_32x32x16_bf16 v[96:111], v[144:147], v[120:123], v[96:111]
    buffer_load_dwordx4 v193, s[40:43], s73 offen offset:2048 lds
    v_exp_f32 v54, v54
    v_exp_f32 v55, v55
    v_cvt_pk_bf16_f32 v114, v52, v53
    v_exp_f32 v56, v56
    v_exp_f32 v57, v57
    v_cvt_pk_bf16_f32 v115, v54, v55
    v_mfma_f32_32x32x16_bf16 v[96:111], v[148:151], v[124:127], v[96:111]
    buffer_load_dwordx4 v193, s[40:43], s73 offen offset:3072 lds
    v_exp_f32 v58, v58
    v_exp_f32 v59, v59
    ds_read_b128 v[144:147], v185 offset:0
    v_cvt_pk_bf16_f32 v116, v56, v57
    v_exp_f32 v60, v60
    v_exp_f32 v61, v61
    ds_read_b128 v[148:151], v185 offset:672
    v_cvt_pk_bf16_f32 v117, v58, v59
    v_exp_f32 v62, v62
    v_mfma_f32_32x32x16_bf16 v[16:31], v[128:131], v[168:171], v[16:31]
    v_exp_f32 v63, v63
    v_cvt_pk_bf16_f32 v118, v60, v61
    v_exp_f32 v64, v64
    v_cvt_pk_bf16_f32 v119, v62, v63
    v_exp_f32 v65, v65
    v_exp_f32 v66, v66
    v_mfma_f32_32x32x16_bf16 v[80:95], v[160:163], v[112:115], v[80:95]
    v_exp_f32 v67, v67
    v_cvt_pk_bf16_f32 v120, v64, v65
    v_exp_f32 v68, v68
    v_exp_f32 v69, v69
    v_cvt_pk_bf16_f32 v121, v66, v67
    v_exp_f32 v70, v70
    v_exp_f32 v71, v71
    v_mfma_f32_32x32x16_bf16 v[32:47], v[128:131], v[172:175], v[32:47]
    v_cvt_pk_bf16_f32 v122, v68, v69
    v_exp_f32 v72, v72
    v_exp_f32 v73, v73
    v_cvt_pk_bf16_f32 v123, v70, v71
    v_exp_f32 v74, v74
    v_exp_f32 v75, v75
    v_mfma_f32_32x32x16_bf16 v[80:95], v[164:167], v[116:119], v[80:95]
    v_cvt_pk_bf16_f32 v124, v72, v73
    v_exp_f32 v76, v76
    v_exp_f32 v77, v77
    v_cvt_pk_bf16_f32 v125, v74, v75
    v_exp_f32 v78, v78
    v_exp_f32 v79, v79
    v_cvt_pk_bf16_f32 v126, v76, v77
    s_waitcnt lgkmcnt(0)
    v_cvt_pk_bf16_f32 v127, v78, v79
    v_swap_b32 v180, v183
    v_swap_b32 v181, v184
    v_swap_b32 v182, v185
    s_mov_b32 s61, s86
    s_mov_b32 s86, s87
    s_mov_b32 s87, s61
    s_add_u32 s85, s85, 1
    s_max_u32 s61, s85, 3
    s_sub_u32 s61, s61, 3
    s_mul_i32 s62, s61, 5120
    s_add_u32 s75, s96, s62
    s_mul_i32 s62, s61, 40960
    s_add_u32 s76, s94, s62
    s_cmp_eq_u32 s98, 0
    s_cbranch_scc1 L_attn_loop
    v_lshrrev_b32 v2, 3, v0
    v_mul_u32_u24 v2, 3072, v2
    v_bfe_u32 v3, v0, 4, 1
    v_lshlrev_b32 v3, 2, v3
    v_and_b32 v4, 7, v0
    v_xor_b32 v3, v3, v4
    v_lshl_add_u32 v230, v3, 4, v2
    v_add_u32 v231, 24576, v230
    v_add_u32 v232, 49152, v230
    v_add_u32 v233, 73728, v230
    v_add_u32 v234, 98304, v230
    v_add_u32 v235, 122880, v230
    v_add_u32 v236, 147456, v230
    v_add_u32 v237, 172032, v230
    v_add_u32 v238, 196608, v230
    v_add_u32 v239, 221184, v230
    s_mul_i32 s76, s52, 1572864
    s_lshl_b32 s62, s59, 7
    s_add_u32 s76, s76, s62
    s_mov_b32 s75, s96
    v_lshrrev_b32 v3, 5, v0
    v_bfe_u32 v4, v0, 2, 2
    v_lshl_add_u32 v3, v3, 3, v4
    v_lshlrev_b32 v3, 7, v3
    v_add_u32 v3, s96, v3
    v_and_b32 v4, 1, v0
    v_lshl_add_u32 v3, v4, 3, v3
    v_bfe_u32 v4, v0, 1, 1
    v_lshl_add_u32 v3, v4, 4, v3
    v_bfe_u32 v4, v0, 4, 1
    v_lshl_add_u32 v3, v4, 5, v3
    v_bfe_u32 v4, v0, 3, 1
    s_lshr_b32 s63, s52, 1
    v_xor_b32 v4, s63, v4
    v_lshl_add_u32 v220, v4, 6, v3
    v_xor_b32 v4, 1, v4
    v_lshl_add_u32 v221, v4, 6, v3
    s_mul_i32 s61, s58, 13
    s_lshr_b32 s61, s61, 6
    s_mul_i32 s61, s61, 5
    s_sub_u32 s61, s58, s61
    s_mul_i32 s61, s61, 40
    s_lshl_b32 s63, s52, 9
    s_add_u32 s61, s61, s63
    s_add_u32 s61, s61, 320
    v_add_u32 v200, s61, v0
    v_mul_u32_u24 v200, 3072, v200
    v_add_u32 v200, s62, v200
    s_mov_b32 s36, s16
    s_mov_b32 s37, s17
    s_mov_b32 s38, s18
    s_mov_b32 s39, s19
.p2align 6
L_w_loop:
    v_mfma_f32_32x32x4_2b_bf16 v[48:79], v[138:139], v[178:179], 0
    v_exp_f32 v16, v16
    v_exp_f32 v17, v17
    ds_read_b128 v[128:131], v180 offset:2048
    v_exp_f32 v18, v18
    v_exp_f32 v19, v19
    v_cvt_pk_bf16_f32 v112, v16, v17
    ds_read_b128 v[140:143], v181 offset:512
    v_exp_f32 v20, v20
    v_exp_f32 v21, v21
    s_add_u32 m0, s72, 3328
    v_cvt_pk_bf16_f32 v113, v18, v19
    v_mfma_f32_32x32x16_bf16 v[96:111], v[160:163], v[120:123], v[96:111]
    buffer_load_dwordx4 v193, s[40:43], s74 offen offset:0 lds
    v_exp_f32 v22, v22
    v_exp_f32 v23, v23
    v_cvt_pk_bf16_f32 v114, v20, v21
    v_exp_f32 v24, v24
    v_exp_f32 v25, v25
    v_cvt_pk_bf16_f32 v115, v22, v23
    v_mfma_f32_32x32x16_bf16 v[96:111], v[164:167], v[124:127], v[96:111]
    buffer_load_dwordx4 v193, s[40:43], s74 offen offset:1024 lds
    v_exp_f32 v26, v26
    v_exp_f32 v27, v27
    ds_read_b128 v[152:155], v182 offset:1344
    v_cvt_pk_bf16_f32 v116, v24, v25
    v_exp_f32 v28, v28
    v_exp_f32 v29, v29
    ds_read_b128 v[156:159], v182 offset:2016
    v_cvt_pk_bf16_f32 v117, v26, v27
    v_exp_f32 v30, v30
    v_mfma_f32_32x32x16_bf16 v[48:63], v[132:135], v[168:171], v[48:63]
    v_exp_f32 v31, v31
    v_cvt_pk_bf16_f32 v118, v28, v29
    v_exp_f32 v32, v32
    v_cvt_pk_bf16_f32 v119, v30, v31
    v_exp_f32 v33, v33
    v_exp_f32 v34, v34
    v_mfma_f32_32x32x16_bf16 v[80:95], v[144:147], v[112:115], v[80:95]
    v_exp_f32 v35, v35
    v_cvt_pk_bf16_f32 v120, v32, v33
    v_exp_f32 v36, v36
    v_exp_f32 v37, v37
    v_cvt_pk_bf16_f32 v121, v34, v35
    v_exp_f32 v38, v38
    v_exp_f32 v39, v39
    v_mfma_f32_32x32x16_bf16 v[64:79], v[132:135], v[172:175], v[64:79]
    v_cvt_pk_bf16_f32 v122, v36, v37
    v_exp_f32 v40, v40
    v_exp_f32 v41, v41
    v_cvt_pk_bf16_f32 v123, v38, v39
    v_exp_f32 v42, v42
    v_exp_f32 v43, v43
    v_mfma_f32_32x32x16_bf16 v[80:95], v[148:151], v[116:119], v[80:95]
    v_cvt_pk_bf16_f32 v124, v40, v41
    v_exp_f32 v44, v44
    v_exp_f32 v45, v45
    v_cvt_pk_bf16_f32 v125, v42, v43
    v_exp_f32 v46, v46
    v_exp_f32 v47, v47
    v_cvt_pk_bf16_f32 v126, v44, v45
    s_waitcnt lgkmcnt(0)
    v_cvt_pk_bf16_f32 v127, v46, v47
    v_mfma_f32_32x32x4_2b_bf16 v[16:47], v[140:141], v[178:179], 0
    v_exp_f32 v48, v48
    v_exp_f32 v49, v49
    ds_read_b128 v[132:135], v180 offset:3072
    v_exp_f32 v50, v50
    v_exp_f32 v51, v51
    v_cvt_pk_bf16_f32 v112, v48, v49
    v_exp_f32 v52, v52
    v_exp_f32 v53, v53
    s_add_u32 m0, s75, 0
    v_cvt_pk_bf16_f32 v113, v50, v51
    v_mfma_f32_32x32x16_bf16 v[96:111], v[144:147], v[120:123], v[96:111]
    buffer_load_dwordx4 v230, s[36:39], s76 offen lds
    v_exp_f32 v54, v54
    v_exp_f32 v55, v55
    v_cvt_pk_bf16_f32 v114, v52, v53
    v_exp_f32 v56, v56
    v_exp_f32 v57, v57
    s_add_u32 m0, s75, 1024
    v_cvt_pk_bf16_f32 v115, v54, v55
    v_mfma_f32_32x32x16_bf16 v[96:111], v[148:151], v[124:127], v[96:111]
    buffer_load_dwordx4 v231, s[36:39], s76 offen lds
    v_exp_f32 v58, v58
    v_exp_f32 v59, v59
    ds_read_b128 v[144:147], v182 offset:2688
    v_cvt_pk_bf16_f32 v116, v56, v57
    v_exp_f32 v60, v60
    v_exp_f32 v61, v61
    ds_read_b128 v[148:151], v182 offset:3360
    v_cvt_pk_bf16_f32 v117, v58, v59
    v_exp_f32 v62, v62
    v_mfma_f32_32x32x16_bf16 v[16:31], v[128:131], v[168:171], v[16:31]
    v_exp_f32 v63, v63
    v_cvt_pk_bf16_f32 v118, v60, v61
    v_exp_f32 v64, v64
    v_cvt_pk_bf16_f32 v119, v62, v63
    v_exp_f32 v65, v65
    v_exp_f32 v66, v66
    v_mfma_f32_32x32x16_bf16 v[80:95], v[152:155], v[112:115], v[80:95]
    v_exp_f32 v67, v67
    v_cvt_pk_bf16_f32 v120, v64, v65
    v_exp_f32 v68, v68
    v_exp_f32 v69, v69
    v_cvt_pk_bf16_f32 v121, v66, v67
    v_exp_f32 v70, v70
    v_exp_f32 v71, v71
    v_mfma_f32_32x32x16_bf16 v[32:47], v[128:131], v[172:175], v[32:47]
    v_cvt_pk_bf16_f32 v122, v68, v69
    v_exp_f32 v72, v72
    v_exp_f32 v73, v73
    v_cvt_pk_bf16_f32 v123, v70, v71
    v_exp_f32 v74, v74
    v_exp_f32 v75, v75
    v_mfma_f32_32x32x16_bf16 v[80:95], v[156:159], v[116:119], v[80:95]
    v_cvt_pk_bf16_f32 v124, v72, v73
    v_exp_f32 v76, v76
    v_exp_f32 v77, v77
    v_cvt_pk_bf16_f32 v125, v74, v75
    v_exp_f32 v78, v78
    v_exp_f32 v79, v79
    v_cvt_pk_bf16_f32 v126, v76, v77
    s_waitcnt lgkmcnt(0)
    v_cvt_pk_bf16_f32 v127, v78, v79
    v_mfma_f32_32x32x4_2b_bf16 v[48:79], v[142:143], v[178:179], 0
    v_exp_f32 v16, v16
    v_exp_f32 v17, v17
    ds_read_b128 v[128:131], v180 offset:4096
    v_exp_f32 v18, v18
    v_exp_f32 v19, v19
    v_cvt_pk_bf16_f32 v112, v16, v17
    ds_read_b128 v[136:139], v181 offset:1024
    v_exp_f32 v20, v20
    v_exp_f32 v21, v21
    s_add_u32 m0, s75, 2048
    v_cvt_pk_bf16_f32 v113, v18, v19
    v_mfma_f32_32x32x16_bf16 v[96:111], v[152:155], v[120:123], v[96:111]
    buffer_load_dwordx4 v232, s[36:39], s76 offen lds
    v_exp_f32 v22, v22
    v_exp_f32 v23, v23
    v_cvt_pk_bf16_f32 v114, v20, v21
    v_exp_f32 v24, v24
    v_exp_f32 v25, v25
    s_add_u32 m0, s75, 3072
    v_cvt_pk_bf16_f32 v115, v22, v23
    v_mfma_f32_32x32x16_bf16 v[96:111], v[156:159], v[124:127], v[96:111]
    buffer_load_dwordx4 v233, s[36:39], s76 offen lds
    v_exp_f32 v26, v26
    v_exp_f32 v27, v27
    ds_read_b128 v[152:155], v182 offset:4032
    v_cvt_pk_bf16_f32 v116, v24, v25
    v_exp_f32 v28, v28
    v_exp_f32 v29, v29
    ds_read_b128 v[156:159], v182 offset:4704
    v_cvt_pk_bf16_f32 v117, v26, v27
    v_exp_f32 v30, v30
    v_mfma_f32_32x32x16_bf16 v[48:63], v[132:135], v[168:171], v[48:63]
    buffer_load_dword v202, v200, s[44:47], 0 offen
    v_exp_f32 v31, v31
    v_cvt_pk_bf16_f32 v118, v28, v29
    v_exp_f32 v32, v32
    v_cvt_pk_bf16_f32 v119, v30, v31
    v_exp_f32 v33, v33
    v_exp_f32 v34, v34
    v_mfma_f32_32x32x16_bf16 v[80:95], v[144:147], v[112:115], v[80:95]
    v_exp_f32 v35, v35
    v_cvt_pk_bf16_f32 v120, v32, v33
    v_exp_f32 v36, v36
    v_exp_f32 v37, v37
    v_cvt_pk_bf16_f32 v121, v34, v35
    v_exp_f32 v38, v38
    v_exp_f32 v39, v39
    v_mfma_f32_32x32x16_bf16 v[64:79], v[132:135], v[172:175], v[64:79]
    v_cvt_pk_bf16_f32 v122, v36, v37
    v_exp_f32 v40, v40
    v_exp_f32 v41, v41
    v_cvt_pk_bf16_f32 v123, v38, v39
    v_exp_f32 v42, v42
    v_exp_f32 v43, v43
    v_mfma_f32_32x32x16_bf16 v[80:95], v[148:151], v[116:119], v[80:95]
    v_cvt_pk_bf16_f32 v124, v40, v41
    v_exp_f32 v44, v44
    v_exp_f32 v45, v45
    v_cvt_pk_bf16_f32 v125, v42, v43
    v_exp_f32 v46, v46
    v_exp_f32 v47, v47
    v_cvt_pk_bf16_f32 v126, v44, v45
    s_waitcnt lgkmcnt(0)
    v_cvt_pk_bf16_f32 v127, v46, v47
    v_mfma_f32_32x32x4_2b_bf16 v[16:47], v[136:137], v[178:179], 0
    v_exp_f32 v48, v48
    v_exp_f32 v49, v49
    ds_read_b128 v[132:135], v180 offset:5120
    v_exp_f32 v50, v50
    v_exp_f32 v51, v51
    v_cvt_pk_bf16_f32 v112, v48, v49
    v_exp_f32 v52, v52
    v_exp_f32 v53, v53
    s_add_u32 m0, s75, 4096
    v_cvt_pk_bf16_f32 v113, v50, v51
    v_mfma_f32_32x32x16_bf16 v[96:111], v[144:147], v[120:123], v[96:111]
    buffer_load_dwordx4 v234, s[36:39], s76 offen lds
    v_exp_f32 v54, v54
    v_exp_f32 v55, v55
    v_cvt_pk_bf16_f32 v114, v52, v53
    v_exp_f32 v56, v56
    v_exp_f32 v57, v57
    s_add_u32 m0, s75, 5120
    v_cvt_pk_bf16_f32 v115, v54, v55
    v_mfma_f32_32x32x16_bf16 v[96:111], v[148:151], v[124:127], v[96:111]
    buffer_load_dwordx4 v235, s[36:39], s76 offen lds
    v_exp_f32 v58, v58
    v_exp_f32 v59, v59
    ds_read_b128 v[144:147], v182 offset:5376
    v_cvt_pk_bf16_f32 v116, v56, v57
    v_exp_f32 v60, v60
    v_exp_f32 v61, v61
    ds_read_b128 v[148:151], v182 offset:6048
    v_cvt_pk_bf16_f32 v117, v58, v59
    v_exp_f32 v62, v62
    v_mfma_f32_32x32x16_bf16 v[16:31], v[128:131], v[168:171], v[16:31]
    v_exp_f32 v63, v63
    v_cvt_pk_bf16_f32 v118, v60, v61
    v_exp_f32 v64, v64
    v_cvt_pk_bf16_f32 v119, v62, v63
    v_exp_f32 v65, v65
    v_exp_f32 v66, v66
    v_mfma_f32_32x32x16_bf16 v[80:95], v[152:155], v[112:115], v[80:95]
    v_exp_f32 v67, v67
    v_cvt_pk_bf16_f32 v120, v64, v65
    v_exp_f32 v68, v68
    v_exp_f32 v69, v69
    v_cvt_pk_bf16_f32 v121, v66, v67
    v_exp_f32 v70, v70
    v_exp_f32 v71, v71
    v_mfma_f32_32x32x16_bf16 v[32:47], v[128:131], v[172:175], v[32:47]
    v_cvt_pk_bf16_f32 v122, v68, v69
    v_exp_f32 v72, v72
    v_exp_f32 v73, v73
    v_cvt_pk_bf16_f32 v123, v70, v71
    v_exp_f32 v74, v74
    v_exp_f32 v75, v75
    v_mfma_f32_32x32x16_bf16 v[80:95], v[156:159], v[116:119], v[80:95]
    v_cvt_pk_bf16_f32 v124, v72, v73
    v_exp_f32 v76, v76
    v_exp_f32 v77, v77
    v_cvt_pk_bf16_f32 v125, v74, v75
    v_exp_f32 v78, v78
    v_exp_f32 v79, v79
    v_cvt_pk_bf16_f32 v126, v76, v77
    s_waitcnt lgkmcnt(0)
    v_cvt_pk_bf16_f32 v127, v78, v79
    v_mfma_f32_32x32x4_2b_bf16 v[48:79], v[138:139], v[178:179], 0
    v_exp_f32 v16, v16
    v_exp_f32 v17, v17
    ds_read_b128 v[128:131], v180 offset:6144
    v_exp_f32 v18, v18
    v_exp_f32 v19, v19
    v_cvt_pk_bf16_f32 v112, v16, v17
    ds_read_b128 v[140:143], v181 offset:1536
    v_exp_f32 v20, v20
    v_exp_f32 v21, v21
    s_add_u32 m0, s75, 6144
    v_cvt_pk_bf16_f32 v113, v18, v19
    v_mfma_f32_32x32x16_bf16 v[96:111], v[152:155], v[120:123], v[96:111]
    buffer_load_dwordx4 v236, s[36:39], s76 offen lds
    v_exp_f32 v22, v22
    v_exp_f32 v23, v23
    v_cvt_pk_bf16_f32 v114, v20, v21
    v_exp_f32 v24, v24
    v_exp_f32 v25, v25
    s_add_u32 m0, s75, 7168
    v_cvt_pk_bf16_f32 v115, v22, v23
    v_mfma_f32_32x32x16_bf16 v[96:111], v[156:159], v[124:127], v[96:111]
    buffer_load_dwordx4 v237, s[36:39], s76 offen lds
    v_exp_f32 v26, v26
    v_exp_f32 v27, v27
    ds_read_b128 v[152:155], v182 offset:6720
    v_cvt_pk_bf16_f32 v116, v24, v25
    v_exp_f32 v28, v28
    v_exp_f32 v29, v29
    ds_read_b128 v[156:159], v182 offset:7392
    v_cvt_pk_bf16_f32 v117, v26, v27
    v_exp_f32 v30, v30
    v_mfma_f32_32x32x16_bf16 v[48:63], v[132:135], v[168:171], v[48:63]
    v_exp_f32 v31, v31
    v_cvt_pk_bf16_f32 v118, v28, v29
    v_exp_f32 v32, v32
    v_cvt_pk_bf16_f32 v119, v30, v31
    v_exp_f32 v33, v33
    v_exp_f32 v34, v34
    v_mfma_f32_32x32x16_bf16 v[80:95], v[144:147], v[112:115], v[80:95]
    v_exp_f32 v35, v35
    v_cvt_pk_bf16_f32 v120, v32, v33
    v_exp_f32 v36, v36
    v_exp_f32 v37, v37
    v_cvt_pk_bf16_f32 v121, v34, v35
    v_exp_f32 v38, v38
    v_exp_f32 v39, v39
    v_mfma_f32_32x32x16_bf16 v[64:79], v[132:135], v[172:175], v[64:79]
    v_cvt_pk_bf16_f32 v122, v36, v37
    v_exp_f32 v40, v40
    v_exp_f32 v41, v41
    v_cvt_pk_bf16_f32 v123, v38, v39
    v_exp_f32 v42, v42
    v_exp_f32 v43, v43
    v_mfma_f32_32x32x16_bf16 v[80:95], v[148:151], v[116:119], v[80:95]
    v_cvt_pk_bf16_f32 v124, v40, v41
    v_exp_f32 v44, v44
    v_exp_f32 v45, v45
    v_cvt_pk_bf16_f32 v125, v42, v43
    v_exp_f32 v46, v46
    v_exp_f32 v47, v47
    v_cvt_pk_bf16_f32 v126, v44, v45
    s_waitcnt lgkmcnt(0)
    v_cvt_pk_bf16_f32 v127, v46, v47
    v_mfma_f32_32x32x4_2b_bf16 v[16:47], v[140:141], v[178:179], 0
    v_exp_f32 v48, v48
    v_exp_f32 v49, v49
    ds_read_b128 v[132:135], v180 offset:7168
    v_exp_f32 v50, v50
    v_exp_f32 v51, v51
    v_cvt_pk_bf16_f32 v112, v48, v49
    v_exp_f32 v52, v52
    v_exp_f32 v53, v53
    s_add_u32 m0, s75, 8192
    v_cvt_pk_bf16_f32 v113, v50, v51
    v_mfma_f32_32x32x16_bf16 v[96:111], v[144:147], v[120:123], v[96:111]
    buffer_load_dwordx4 v238, s[36:39], s76 offen lds
    v_exp_f32 v54, v54
    v_exp_f32 v55, v55
    v_cvt_pk_bf16_f32 v114, v52, v53
    v_exp_f32 v56, v56
    v_exp_f32 v57, v57
    s_add_u32 m0, s75, 9216
    v_cvt_pk_bf16_f32 v115, v54, v55
    v_mfma_f32_32x32x16_bf16 v[96:111], v[148:151], v[124:127], v[96:111]
    buffer_load_dwordx4 v239, s[36:39], s76 offen lds
    v_exp_f32 v58, v58
    v_exp_f32 v59, v59
    ds_read_b128 v[144:147], v182 offset:8064
    v_cvt_pk_bf16_f32 v116, v56, v57
    v_exp_f32 v60, v60
    v_exp_f32 v61, v61
    ds_read_b128 v[148:151], v182 offset:8736
    v_cvt_pk_bf16_f32 v117, v58, v59
    v_exp_f32 v62, v62
    v_mfma_f32_32x32x16_bf16 v[16:31], v[128:131], v[168:171], v[16:31]
    v_exp_f32 v63, v63
    v_cvt_pk_bf16_f32 v118, v60, v61
    ds_read_b128 v[160:163], v182 offset:9408
    v_exp_f32 v64, v64
    v_cvt_pk_bf16_f32 v119, v62, v63
    v_exp_f32 v65, v65
    v_exp_f32 v66, v66
    v_mfma_f32_32x32x16_bf16 v[80:95], v[152:155], v[112:115], v[80:95]
    v_exp_f32 v67, v67
    v_cvt_pk_bf16_f32 v120, v64, v65
    ds_read_b128 v[164:167], v182 offset:10080
    v_exp_f32 v68, v68
    v_exp_f32 v69, v69
    v_cvt_pk_bf16_f32 v121, v66, v67
    v_exp_f32 v70, v70
    v_exp_f32 v71, v71
    v_mfma_f32_32x32x16_bf16 v[32:47], v[128:131], v[172:175], v[32:47]
    v_cvt_pk_bf16_f32 v122, v68, v69
    v_exp_f32 v72, v72
    v_exp_f32 v73, v73
    v_cvt_pk_bf16_f32 v123, v70, v71
    v_exp_f32 v74, v74
    v_exp_f32 v75, v75
    v_mfma_f32_32x32x16_bf16 v[80:95], v[156:159], v[116:119], v[80:95]
    v_cvt_pk_bf16_f32 v124, v72, v73
    v_exp_f32 v76, v76
    v_exp_f32 v77, v77
    v_cvt_pk_bf16_f32 v125, v74, v75
    v_exp_f32 v78, v78
    v_exp_f32 v79, v79
    v_cvt_pk_bf16_f32 v126, v76, v77
    s_waitcnt lgkmcnt(0)
    v_cvt_pk_bf16_f32 v127, v78, v79
    s_add_u32 s88, s88, 1
    s_and_b32 s88, s88, 7
    s_mul_i32 s73, s88, 21504
    s_add_u32 s73, s73, s92
    s_add_u32 s74, s73, 3328
    s_add_u32 s72, s93, s86
    s_waitcnt vmcnt(11)
    s_barrier
    v_mfma_f32_32x32x4_2b_bf16 v[48:79], v[142:143], v[178:179], 0
    v_exp_f32 v16, v16
    v_exp_f32 v17, v17
    ds_read_b128 v[128:131], v183 offset:0
    v_exp_f32 v18, v18
    v_exp_f32 v19, v19
    v_cvt_pk_bf16_f32 v112, v16, v17
    ds_read_b128 v[136:139], v184 offset:0
    v_exp_f32 v20, v20
    v_exp_f32 v21, v21
    s_add_u32 m0, s72, 0
    v_cvt_pk_bf16_f32 v113, v18, v19
    v_mfma_f32_32x32x16_bf16 v[96:111], v[152:155], v[120:123], v[96:111]
    buffer_load_dwordx4 v193, s[40:43], s73 offen offset:0 lds
    v_exp_f32 v22, v22
    v_exp_f32 v23, v23
    v_cvt_pk_bf16_f32 v114, v20, v21
    v_exp_f32 v24, v24
    v_exp_f32 v25, v25
    v_cvt_pk_bf16_f32 v115, v22, v23
    v_mfma_f32_32x32x16_bf16 v[96:111], v[156:159], v[124:127], v[96:111]
    buffer_load_dwordx4 v193, s[40:43], s73 offen offset:1024 lds
    v_exp_f32 v26, v26
    v_exp_f32 v27, v27
    v_cvt_pk_bf16_f32 v116, v24, v25
    v_exp_f32 v28, v28
    v_exp_f32 v29, v29
    v_cvt_pk_bf16_f32 v117, v26, v27
    v_exp_f32 v30, v30
    v_mfma_f32_32x32x16_bf16 v[48:63], v[132:135], v[168:171], v[48:63]
    v_exp_f32 v31, v31
    v_cvt_pk_bf16_f32 v118, v28, v29
    v_exp_f32 v32, v32
    v_cvt_pk_bf16_f32 v119, v30, v31
    v_exp_f32 v33, v33
    v_exp_f32 v34, v34
    v_mfma_f32_32x32x16_bf16 v[80:95], v[144:147], v[112:115], v[80:95]
    v_exp_f32 v35, v35
    v_cvt_pk_bf16_f32 v120, v32, v33
    v_exp_f32 v36, v36
    v_exp_f32 v37, v37
    v_cvt_pk_bf16_f32 v121, v34, v35
    v_exp_f32 v38, v38
    v_exp_f32 v39, v39
    v_mfma_f32_32x32x16_bf16 v[64:79], v[132:135], v[172:175], v[64:79]
    v_cvt_pk_bf16_f32 v122, v36, v37
    v_exp_f32 v40, v40
    v_exp_f32 v41, v41
    v_cvt_pk_bf16_f32 v123, v38, v39
    v_exp_f32 v42, v42
    v_exp_f32 v43, v43
    v_mfma_f32_32x32x16_bf16 v[80:95], v[148:151], v[116:119], v[80:95]
    v_cvt_pk_bf16_f32 v124, v40, v41
    v_exp_f32 v44, v44
    v_exp_f32 v45, v45
    v_cvt_pk_bf16_f32 v125, v42, v43
    v_exp_f32 v46, v46
    v_exp_f32 v47, v47
    v_cvt_pk_bf16_f32 v126, v44, v45
    s_waitcnt lgkmcnt(0)
    v_cvt_pk_bf16_f32 v127, v46, v47
    v_mfma_f32_32x32x4_2b_bf16 v[16:47], v[136:137], v[178:179], 0
    v_exp_f32 v48, v48
    v_exp_f32 v49, v49
    ds_read_b128 v[132:135], v183 offset:1024
    v_exp_f32 v50, v50
    v_exp_f32 v51, v51
    v_cvt_pk_bf16_f32 v112, v48, v49
    v_exp_f32 v52, v52
    v_exp_f32 v53, v53
    s_add_u32 m0, s72, 0
    v_cvt_pk_bf16_f32 v113, v50, v51
    v_mfma_f32_32x32x16_bf16 v[96:111], v[144:147], v[120:123], v[96:111]
    buffer_load_dwordx4 v193, s[40:43], s73 offen offset:2048 lds
    v_exp_f32 v54, v54
    v_exp_f32 v55, v55
    v_cvt_pk_bf16_f32 v114, v52, v53
    v_exp_f32 v56, v56
    v_exp_f32 v57, v57
    v_cvt_pk_bf16_f32 v115, v54, v55
    v_mfma_f32_32x32x16_bf16 v[96:111], v[148:151], v[124:127], v[96:111]
    buffer_load_dwordx4 v193, s[40:43], s73 offen offset:3072 lds
    v_exp_f32 v58, v58
    v_exp_f32 v59, v59
    ds_read_b128 v[144:147], v185 offset:0
    v_cvt_pk_bf16_f32 v116, v56, v57
    v_exp_f32 v60, v60
    v_exp_f32 v61, v61
    ds_read_b128 v[148:151], v185 offset:672
    v_cvt_pk_bf16_f32 v117, v58, v59
    v_exp_f32 v62, v62
    v_mfma_f32_32x32x16_bf16 v[16:31], v[128:131], v[168:171], v[16:31]
    v_exp_f32 v63, v63
    v_cvt_pk_bf16_f32 v118, v60, v61
    v_exp_f32 v64, v64
    v_cvt_pk_bf16_f32 v119, v62, v63
    v_exp_f32 v65, v65
    v_exp_f32 v66, v66
    v_mfma_f32_32x32x16_bf16 v[80:95], v[160:163], v[112:115], v[80:95]
    v_exp_f32 v67, v67
    v_cvt_pk_bf16_f32 v120, v64, v65
    v_exp_f32 v68, v68
    v_exp_f32 v69, v69
    v_cvt_pk_bf16_f32 v121, v66, v67
    v_exp_f32 v70, v70
    v_exp_f32 v71, v71
    v_mfma_f32_32x32x16_bf16 v[32:47], v[128:131], v[172:175], v[32:47]
    v_cvt_pk_bf16_f32 v122, v68, v69
    v_exp_f32 v72, v72
    v_exp_f32 v73, v73
    v_cvt_pk_bf16_f32 v123, v70, v71
    v_exp_f32 v74, v74
    v_exp_f32 v75, v75
    v_mfma_f32_32x32x16_bf16 v[80:95], v[164:167], v[116:119], v[80:95]
    v_cvt_pk_bf16_f32 v124, v72, v73
    v_exp_f32 v76, v76
    v_exp_f32 v77, v77
    v_cvt_pk_bf16_f32 v125, v74, v75
    v_exp_f32 v78, v78
    v_exp_f32 v79, v79
    v_cvt_pk_bf16_f32 v126, v76, v77
    s_waitcnt lgkmcnt(0)
    v_cvt_pk_bf16_f32 v127, v78, v79
    v_swap_b32 v180, v183
    v_swap_b32 v181, v184
    v_swap_b32 v182, v185
    s_mov_b32 s61, s86
    s_mov_b32 s86, s87
    s_mov_b32 s87, s61
    s_add_u32 s85, s85, 1
    s_cmp_eq_u32 s85, 2
    s_cbranch_scc1 L_wev2
    s_cmp_eq_u32 s85, 3
    s_cbranch_scc1 L_wev3
    s_cmp_eq_u32 s85, 4
    s_cbranch_scc1 L_wev4
    s_cmp_eq_u32 s85, 5
    s_cbranch_scc1 L_wev5
    s_cmp_eq_u32 s85, 6
    s_cbranch_scc1 L_wev6
    s_cmp_eq_u32 s85, 7
    s_cbranch_scc1 L_wev7
    s_branch L_attn_done
.p2align 6
L_attn_loop:
    v_mfma_f32_32x32x4_2b_bf16 v[48:79], v[138:139], v[178:179], 0
    v_exp_f32 v16, v16
    v_exp_f32 v17, v17
    ds_read_b128 v[128:131], v180 offset:2048
    v_exp_f32 v18, v18
    v_exp_f32 v19, v19
    v_cvt_pk_bf16_f32 v112, v16, v17
    ds_read_b128 v[140:143], v181 offset:512
    v_exp_f32 v20, v20
    v_exp_f32 v21, v21
    s_add_u32 m0, s72, 3328
    v_cvt_pk_bf16_f32 v113, v18, v19
    v_mfma_f32_32x32x16_bf16 v[96:111], v[160:163], v[120:123], v[96:111]
    buffer_load_dwordx4 v193, s[40:43], s74 offen offset:0 lds
    v_exp_f32 v22, v22
    v_exp_f32 v23, v23
    v_cvt_pk_bf16_f32 v114, v20, v21
    v_exp_f32 v24, v24
    v_exp_f32 v25, v25
    v_cvt_pk_bf16_f32 v115, v22, v23
    v_mfma_f32_32x32x16_bf16 v[96:111], v[164:167], v[124:127], v[96:111]
    buffer_load_dwordx4 v193, s[40:43], s74 offen offset:1024 lds
    v_exp_f32 v26, v26
    v_exp_f32 v27, v27
    ds_read_b128 v[152:155], v182 offset:1344
    v_cvt_pk_bf16_f32 v116, v24, v25
    v_exp_f32 v28, v28
    v_exp_f32 v29, v29
    ds_read_b128 v[156:159], v182 offset:2016
    v_cvt_pk_bf16_f32 v117, v26, v27
    v_exp_f32 v30, v30
    v_mfma_f32_32x32x16_bf16 v[48:63], v[132:135], v[168:171], v[48:63]
    v_exp_f32 v31, v31
    v_cvt_pk_bf16_f32 v118, v28, v29
    v_exp_f32 v32, v32
    v_cvt_pk_bf16_f32 v119, v30, v31
    v_exp_f32 v33, v33
    v_exp_f32 v34, v34
    v_mfma_f32_32x32x16_bf16 v[80:95], v[144:147], v[112:115], v[80:95]
    v_exp_f32 v35, v35
    v_cvt_pk_bf16_f32 v120, v32, v33
    v_exp_f32 v36, v36
    v_exp_f32 v37, v37
    v_cvt_pk_bf16_f32 v121, v34, v35
    v_exp_f32 v38, v38
    v_exp_f32 v39, v39
    v_mfma_f32_32x32x16_bf16 v[64:79], v[132:135], v[172:175], v[64:79]
    v_cvt_pk_bf16_f32 v122, v36, v37
    v_exp_f32 v40, v40
    v_exp_f32 v41, v41
    v_cvt_pk_bf16_f32 v123, v38, v39
    v_exp_f32 v42, v42
    v_exp_f32 v43, v43
    v_mfma_f32_32x32x16_bf16 v[80:95], v[148:151], v[116:119], v[80:95]
    v_cvt_pk_bf16_f32 v124, v40, v41
    v_exp_f32 v44, v44
    v_exp_f32 v45, v45
    v_cvt_pk_bf16_f32 v125, v42, v43
    v_exp_f32 v46, v46
    v_exp_f32 v47, v47
    v_cvt_pk_bf16_f32 v126, v44, v45
    s_waitcnt lgkmcnt(0)
    v_cvt_pk_bf16_f32 v127, v46, v47
    v_mfma_f32_32x32x4_2b_bf16 v[16:47], v[140:141], v[178:179], 0
    v_exp_f32 v48, v48
    v_exp_f32 v49, v49
    ds_read_b128 v[132:135], v180 offset:3072
    v_exp_f32 v50, v50
    v_exp_f32 v51, v51
    v_cvt_pk_bf16_f32 v112, v48, v49
    v_exp_f32 v52, v52
    v_exp_f32 v53, v53
    v_cvt_pk_bf16_f32 v113, v50, v51
    v_mfma_f32_32x32x16_bf16 v[96:111], v[144:147], v[120:123], v[96:111]
    buffer_load_dword v202, v200, s[44:47], 0 offen
    v_exp_f32 v54, v54
    v_exp_f32 v55, v55
    v_cvt_pk_bf16_f32 v114, v52, v53
    v_exp_f32 v56, v56
    v_exp_f32 v57, v57
    v_cvt_pk_bf16_f32 v115, v54, v55
    v_mfma_f32_32x32x16_bf16 v[96:111], v[148:151], v[124:127], v[96:111]
    v_exp_f32 v58, v58
    v_exp_f32 v59, v59
    ds_read_b128 v[144:147], v182 offset:2688
    v_cvt_pk_bf16_f32 v116, v56, v57
    v_exp_f32 v60, v60
    v_exp_f32 v61, v61
    ds_read_b128 v[148:151], v182 offset:3360
    v_cvt_pk_bf16_f32 v117, v58, v59
    v_exp_f32 v62, v62
    v_mfma_f32_32x32x16_bf16 v[16:31], v[128:131], v[168:171], v[16:31]
    v_exp_f32 v63, v63
    v_cvt_pk_bf16_f32 v118, v60, v61
    v_exp_f32 v64, v64
    v_cvt_pk_bf16_f32 v119, v62, v63
    v_exp_f32 v65, v65
    v_exp_f32 v66, v66
    v_mfma_f32_32x32x16_bf16 v[80:95], v[152:155], v[112:115], v[80:95]
    v_exp_f32 v67, v67
    v_cvt_pk_bf16_f32 v120, v64, v65
    v_exp_f32 v68, v68
    v_exp_f32 v69, v69
    v_cvt_pk_bf16_f32 v121, v66, v67
    v_exp_f32 v70, v70
    v_exp_f32 v71, v71
    v_mfma_f32_32x32x16_bf16 v[32:47], v[128:131], v[172:175], v[32:47]
    v_cvt_pk_bf16_f32 v122, v68, v69
    v_exp_f32 v72, v72
    v_exp_f32 v73, v73
    v_cvt_pk_bf16_f32 v123, v70, v71
    v_exp_f32 v74, v74
    v_exp_f32 v75, v75
    v_mfma_f32_32x32x16_bf16 v[80:95], v[156:159], v[116:119], v[80:95]
    v_cvt_pk_bf16_f32 v124, v72, v73
    v_exp_f32 v76, v76
    v_exp_f32 v77, v77
    v_cvt_pk_bf16_f32 v125, v74, v75
    v_exp_f32 v78, v78
    v_exp_f32 v79, v79
    v_cvt_pk_bf16_f32 v126, v76, v77
    s_waitcnt lgkmcnt(0)
    v_cvt_pk_bf16_f32 v127, v78, v79
    v_mfma_f32_32x32x4_2b_bf16 v[48:79], v[142:143], v[178:179], 0
    v_exp_f32 v16, v16
    v_exp_f32 v17, v17
    ds_read_b128 v[128:131], v180 offset:4096
    v_exp_f32 v18, v18
    v_exp_f32 v19, v19
    v_cvt_pk_bf16_f32 v112, v16, v17
    ds_read_b128 v[136:139], v181 offset:1024
    v_exp_f32 v20, v20
    v_exp_f32 v21, v21
    v_cvt_pk_bf16_f32 v113, v18, v19
    v_mfma_f32_32x32x16_bf16 v[96:111], v[152:155], v[120:123], v[96:111]
    v_exp_f32 v22, v22
    v_exp_f32 v23, v23
    v_cvt_pk_bf16_f32 v114, v20, v21
    v_exp_f32 v24, v24
    v_exp_f32 v25, v25
    v_cvt_pk_bf16_f32 v115, v22, v23
    v_mfma_f32_32x32x16_bf16 v[96:111], v[156:159], v[124:127], v[96:111]
    v_exp_f32 v26, v26
    v_exp_f32 v27, v27
    ds_read_b128 v[152:155], v182 offset:4032
    v_cvt_pk_bf16_f32 v116, v24, v25
    v_exp_f32 v28, v28
    v_exp_f32 v29, v29
    ds_read_b128 v[156:159], v182 offset:4704
    v_cvt_pk_bf16_f32 v117, v26, v27
    v_exp_f32 v30, v30
    v_mfma_f32_32x32x16_bf16 v[48:63], v[132:135], v[168:171], v[48:63]
    v_exp_f32 v31, v31
    v_cvt_pk_bf16_f32 v118, v28, v29
    v_exp_f32 v32, v32
    v_cvt_pk_bf16_f32 v119, v30, v31
    v_exp_f32 v33, v33
    v_exp_f32 v34, v34
    v_mfma_f32_32x32x16_bf16 v[80:95], v[144:147], v[112:115], v[80:95]
    v_exp_f32 v35, v35
    v_cvt_pk_bf16_f32 v120, v32, v33
    v_exp_f32 v36, v36
    v_exp_f32 v37, v37
    v_cvt_pk_bf16_f32 v121, v34, v35
    v_exp_f32 v38, v38
    v_exp_f32 v39, v39
    v_mfma_f32_32x32x16_bf16 v[64:79], v[132:135], v[172:175], v[64:79]
    v_cvt_pk_bf16_f32 v122, v36, v37
    v_exp_f32 v40, v40
    v_exp_f32 v41, v41
    v_cvt_pk_bf16_f32 v123, v38, v39
    v_exp_f32 v42, v42
    v_exp_f32 v43, v43
    v_mfma_f32_32x32x16_bf16 v[80:95], v[148:151], v[116:119], v[80:95]
    v_cvt_pk_bf16_f32 v124, v40, v41
    v_exp_f32 v44, v44
    v_exp_f32 v45, v45
    v_cvt_pk_bf16_f32 v125, v42, v43
    v_exp_f32 v46, v46
    v_exp_f32 v47, v47
    v_cvt_pk_bf16_f32 v126, v44, v45
    s_waitcnt lgkmcnt(0)
    v_cvt_pk_bf16_f32 v127, v46, v47
    v_mfma_f32_32x32x4_2b_bf16 v[16:47], v[136:137], v[178:179], 0
    v_exp_f32 v48, v48
    v_exp_f32 v49, v49
    ds_read_b128 v[132:135], v180 offset:5120
    v_exp_f32 v50, v50
    v_exp_f32 v51, v51
    v_cvt_pk_bf16_f32 v112, v48, v49
    v_exp_f32 v52, v52
    v_exp_f32 v53, v53
    s_add_u32 m0, s75, 0
    v_cvt_pk_bf16_f32 v113, v50, v51
    v_mfma_f32_32x32x16_bf16 v[96:111], v[144:147], v[120:123], v[96:111]
    buffer_load_dwordx4 v188, s[12:15], s76 offen offset:0 lds
    v_exp_f32 v54, v54
    v_exp_f32 v55, v55
    v_cvt_pk_bf16_f32 v114, v52, v53
    v_exp_f32 v56, v56
    v_exp_f32 v57, v57
    s_add_u32 m0, s75, 0
    v_cvt_pk_bf16_f32 v115, v54, v55
    v_mfma_f32_32x32x16_bf16 v[96:111], v[148:151], v[124:127], v[96:111]
    buffer_load_dwordx4 v189, s[12:15], s76 offen offset:1024 lds
    v_exp_f32 v58, v58
    v_exp_f32 v59, v59
    ds_read_b128 v[144:147], v182 offset:5376
    v_cvt_pk_bf16_f32 v116, v56, v57
    v_exp_f32 v60, v60
    v_exp_f32 v61, v61
    ds_read_b128 v[148:151], v182 offset:6048
    v_cvt_pk_bf16_f32 v117, v58, v59
    v_exp_f32 v62, v62
    v_mfma_f32_32x32x16_bf16 v[16:31], v[128:131], v[168:171], v[16:31]
    v_exp_f32 v63, v63
    v_cvt_pk_bf16_f32 v118, v60, v61
    v_exp_f32 v64, v64
    v_cvt_pk_bf16_f32 v119, v62, v63
    v_exp_f32 v65, v65
    v_exp_f32 v66, v66
    v_mfma_f32_32x32x16_bf16 v[80:95], v[152:155], v[112:115], v[80:95]
    v_exp_f32 v67, v67
    v_cvt_pk_bf16_f32 v120, v64, v65
    v_exp_f32 v68, v68
    v_exp_f32 v69, v69
    v_cvt_pk_bf16_f32 v121, v66, v67
    v_exp_f32 v70, v70
    v_exp_f32 v71, v71
    v_mfma_f32_32x32x16_bf16 v[32:47], v[128:131], v[172:175], v[32:47]
    v_cvt_pk_bf16_f32 v122, v68, v69
    v_exp_f32 v72, v72
    v_exp_f32 v73, v73
    v_cvt_pk_bf16_f32 v123, v70, v71
    v_exp_f32 v74, v74
    v_exp_f32 v75, v75
    v_mfma_f32_32x32x16_bf16 v[80:95], v[156:159], v[116:119], v[80:95]
    v_cvt_pk_bf16_f32 v124, v72, v73
    v_exp_f32 v76, v76
    v_exp_f32 v77, v77
    v_cvt_pk_bf16_f32 v125, v74, v75
    v_exp_f32 v78, v78
    v_exp_f32 v79, v79
    v_cvt_pk_bf16_f32 v126, v76, v77
    s_waitcnt lgkmcnt(0)
    v_cvt_pk_bf16_f32 v127, v78, v79
    v_mfma_f32_32x32x4_2b_bf16 v[48:79], v[138:139], v[178:179], 0
    v_exp_f32 v16, v16
    v_exp_f32 v17, v17
    ds_read_b128 v[128:131], v180 offset:6144
    v_exp_f32 v18, v18
    v_exp_f32 v19, v19
    v_cvt_pk_bf16_f32 v112, v16, v17
    ds_read_b128 v[140:143], v181 offset:1536
    v_exp_f32 v20, v20
    v_exp_f32 v21, v21
    s_add_u32 m0, s75, 0
    v_cvt_pk_bf16_f32 v113, v18, v19
    v_mfma_f32_32x32x16_bf16 v[96:111], v[152:155], v[120:123], v[96:111]
    buffer_load_dwordx4 v190, s[12:15], s76 offen offset:2048 lds
    v_exp_f32 v22, v22
    v_exp_f32 v23, v23
    v_cvt_pk_bf16_f32 v114, v20, v21
    v_exp_f32 v24, v24
    v_exp_f32 v25, v25
    s_add_u32 m0, s75, 0
    v_cvt_pk_bf16_f32 v115, v22, v23
    v_mfma_f32_32x32x16_bf16 v[96:111], v[156:159], v[124:127], v[96:111]
    buffer_load_dwordx4 v191, s[12:15], s76 offen offset:3072 lds
    v_exp_f32 v26, v26
    v_exp_f32 v27, v27
    ds_read_b128 v[152:155], v182 offset:6720
    v_cvt_pk_bf16_f32 v116, v24, v25
    v_exp_f32 v28, v28
    v_exp_f32 v29, v29
    ds_read_b128 v[156:159], v182 offset:7392
    v_cvt_pk_bf16_f32 v117, v26, v27
    v_exp_f32 v30, v30
    v_mfma_f32_32x32x16_bf16 v[48:63], v[132:135], v[168:171], v[48:63]
    v_exp_f32 v31, v31
    v_cvt_pk_bf16_f32 v118, v28, v29
    v_exp_f32 v32, v32
    v_cvt_pk_bf16_f32 v119, v30, v31
    v_exp_f32 v33, v33
    v_exp_f32 v34, v34
    v_mfma_f32_32x32x16_bf16 v[80:95], v[144:147], v[112:115], v[80:95]
    v_exp_f32 v35, v35
    v_cvt_pk_bf16_f32 v120, v32, v33
    v_exp_f32 v36, v36
    v_exp_f32 v37, v37
    v_cvt_pk_bf16_f32 v121, v34, v35
    v_exp_f32 v38, v38
    v_exp_f32 v39, v39
    v_mfma_f32_32x32x16_bf16 v[64:79], v[132:135], v[172:175], v[64:79]
    v_cvt_pk_bf16_f32 v122, v36, v37
    v_exp_f32 v40, v40
    v_exp_f32 v41, v41
    v_cvt_pk_bf16_f32 v123, v38, v39
    v_exp_f32 v42, v42
    v_exp_f32 v43, v43
    v_mfma_f32_32x32x16_bf16 v[80:95], v[148:151], v[116:119], v[80:95]
    v_cvt_pk_bf16_f32 v124, v40, v41
    v_exp_f32 v44, v44
    v_exp_f32 v45, v45
    v_cvt_pk_bf16_f32 v125, v42, v43
    v_exp_f32 v46, v46
    v_exp_f32 v47, v47
    v_cvt_pk_bf16_f32 v126, v44, v45
    s_waitcnt lgkmcnt(0)
    v_cvt_pk_bf16_f32 v127, v46, v47
    v_mfma_f32_32x32x4_2b_bf16 v[16:47], v[140:141], v[178:179], 0
    v_exp_f32 v48, v48
    v_exp_f32 v49, v49
    ds_read_b128 v[132:135], v180 offset:7168
    v_exp_f32 v50, v50
    v_exp_f32 v51, v51
    v_cvt_pk_bf16_f32 v112, v48, v49
    v_exp_f32 v52, v52
    v_exp_f32 v53, v53
    s_add_u32 m0, s75, 4096
    v_cvt_pk_bf16_f32 v113, v50, v51
    v_mfma_f32_32x32x16_bf16 v[96:111], v[144:147], v[120:123], v[96:111]
    buffer_load_dwordx4 v192, s[12:15], s76 offen offset:0 lds
    v_exp_f32 v54, v54
    v_exp_f32 v55, v55
    v_cvt_pk_bf16_f32 v114, v52, v53
    v_exp_f32 v56, v56
    v_exp_f32 v57, v57
    v_cvt_pk_bf16_f32 v115, v54, v55
    v_mfma_f32_32x32x16_bf16 v[96:111], v[148:151], v[124:127], v[96:111]
    v_exp_f32 v58, v58
    v_exp_f32 v59, v59
    ds_read_b128 v[144:147], v182 offset:8064
    v_cvt_pk_bf16_f32 v116, v56, v57
    v_exp_f32 v60, v60
    v_exp_f32 v61, v61
    ds_read_b128 v[148:151], v182 offset:8736
    v_cvt_pk_bf16_f32 v117, v58, v59
    v_exp_f32 v62, v62
    v_mfma_f32_32x32x16_bf16 v[16:31], v[128:131], v[168:171], v[16:31]
    v_exp_f32 v63, v63
    v_cvt_pk_bf16_f32 v118, v60, v61
    ds_read_b128 v[160:163], v182 offset:9408
    v_exp_f32 v64, v64
    v_cvt_pk_bf16_f32 v119, v62, v63
    v_exp_f32 v65, v65
    v_exp_f32 v66, v66
    v_mfma_f32_32x32x16_bf16 v[80:95], v[152:155], v[112:115], v[80:95]
    v_exp_f32 v67, v67
    v_cvt_pk_bf16_f32 v120, v64, v65
    ds_read_b128 v[164:167], v182 offset:10080
    v_exp_f32 v68, v68
    v_exp_f32 v69, v69
    v_cvt_pk_bf16_f32 v121, v66, v67
    v_exp_f32 v70, v70
    v_exp_f32 v71, v71
    v_mfma_f32_32x32x16_bf16 v[32:47], v[128:131], v[172:175], v[32:47]
    v_cvt_pk_bf16_f32 v122, v68, v69
    v_exp_f32 v72, v72
    v_exp_f32 v73, v73
    v_cvt_pk_bf16_f32 v123, v70, v71
    v_exp_f32 v74, v74
    v_exp_f32 v75, v75
    v_mfma_f32_32x32x16_bf16 v[80:95], v[156:159], v[116:119], v[80:95]
    v_cvt_pk_bf16_f32 v124, v72, v73
    v_exp_f32 v76, v76
    v_exp_f32 v77, v77
    v_cvt_pk_bf16_f32 v125, v74, v75
    v_exp_f32 v78, v78
    v_exp_f32 v79, v79
    v_cvt_pk_bf16_f32 v126, v76, v77
    s_waitcnt lgkmcnt(0)
    v_cvt_pk_bf16_f32 v127, v78, v79
    s_add_u32 s88, s88, 1
    s_and_b32 s88, s88, 7
    s_mul_i32 s73, s88, 21504
    s_add_u32 s73, s73, s92
    s_add_u32 s74, s73, 3328
    s_add_u32 s72, s93, s86
    s_waitcnt vmcnt(6)
    s_barrier
    v_mfma_f32_32x32x4_2b_bf16 v[48:79], v[142:143], v[178:179], 0
    v_exp_f32 v16, v16
    v_exp_f32 v17, v17
    ds_read_b128 v[128:131], v183 offset:0
    v_exp_f32 v18, v18
    v_exp_f32 v19, v19
    v_cvt_pk_bf16_f32 v112, v16, v17
    ds_read_b128 v[136:139], v184 offset:0
    v_exp_f32 v20, v20
    v_exp_f32 v21, v21
    s_add_u32 m0, s72, 0
    v_cvt_pk_bf16_f32 v113, v18, v19
    v_mfma_f32_32x32x16_bf16 v[96:111], v[152:155], v[120:123], v[96:111]
    buffer_load_dwordx4 v193, s[40:43], s73 offen offset:0 lds
    v_exp_f32 v22, v22
    v_exp_f32 v23, v23
    v_cvt_pk_bf16_f32 v114, v20, v21
    v_exp_f32 v24, v24
    v_exp_f32 v25, v25
    v_cvt_pk_bf16_f32 v115, v22, v23
    v_mfma_f32_32x32x16_bf16 v[96:111], v[156:159], v[124:127], v[96:111]
    buffer_load_dwordx4 v193, s[40:43], s73 offen offset:1024 lds
    v_exp_f32 v26, v26
    v_exp_f32 v27, v27
    v_cvt_pk_bf16_f32 v116, v24, v25
    v_exp_f32 v28, v28
    v_exp_f32 v29, v29
    v_cvt_pk_bf16_f32 v117, v26, v27
    v_exp_f32 v30, v30
    v_mfma_f32_32x32x16_bf16 v[48:63], v[132:135], v[168:171], v[48:63]
    v_exp_f32 v31, v31
    v_cvt_pk_bf16_f32 v118, v28, v29
    v_exp_f32 v32, v32
    v_cvt_pk_bf16_f32 v119, v30, v31
    v_exp_f32 v33, v33
    v_exp_f32 v34, v34
    v_mfma_f32_32x32x16_bf16 v[80:95], v[144:147], v[112:115], v[80:95]
    v_exp_f32 v35, v35
    v_cvt_pk_bf16_f32 v120, v32, v33
    v_exp_f32 v36, v36
    v_exp_f32 v37, v37
    v_cvt_pk_bf16_f32 v121, v34, v35
    v_exp_f32 v38, v38
    v_exp_f32 v39, v39
    v_mfma_f32_32x32x16_bf16 v[64:79], v[132:135], v[172:175], v[64:79]
    v_cvt_pk_bf16_f32 v122, v36, v37
    v_exp_f32 v40, v40
    v_exp_f32 v41, v41
    v_cvt_pk_bf16_f32 v123, v38, v39
    v_exp_f32 v42, v42
    v_exp_f32 v43, v43
    v_mfma_f32_32x32x16_bf16 v[80:95], v[148:151], v[116:119], v[80:95]
    v_cvt_pk_bf16_f32 v124, v40, v41
    v_exp_f32 v44, v44
    v_exp_f32 v45, v45
    v_cvt_pk_bf16_f32 v125, v42, v43
    v_exp_f32 v46, v46
    v_exp_f32 v47, v47
    v_cvt_pk_bf16_f32 v126, v44, v45
    s_waitcnt lgkmcnt(0)
    v_cvt_pk_bf16_f32 v127, v46, v47
    v_mfma_f32_32x32x4_2b_bf16 v[16:47], v[136:137], v[178:179], 0
    v_exp_f32 v48, v48
    v_exp_f32 v49, v49
    ds_read_b128 v[132:135], v183 offset:1024
    v_exp_f32 v50, v50
    v_exp_f32 v51, v51
    v_cvt_pk_bf16_f32 v112, v48, v49
    v_exp_f32 v52, v52
    v_exp_f32 v53, v53
    s_add_u32 m0, s72, 0
    v_cvt_pk_bf16_f32 v113, v50, v51
    v_mfma_f32_32x32x16_bf16 v[96:111], v[144:147], v[120:123], v[96:111]
    buffer_load_dwordx4 v193, s[40:43], s73 offen offset:2048 lds
    v_exp_f32 v54, v54
    v_exp_f32 v55, v55
    v_cvt_pk_bf16_f32 v114, v52, v53
    v_exp_f32 v56, v56
    v_exp_f32 v57, v57
    v_cvt_pk_bf16_f32 v115, v54, v55
    v_mfma_f32_32x32x16_bf16 v[96:111], v[148:151], v[124:127], v[96:111]
    buffer_load_dwordx4 v193, s[40:43], s73 offen offset:3072 lds
    v_exp_f32 v58, v58
    v_exp_f32 v59, v59
    ds_read_b128 v[144:147], v185 offset:0
    v_cvt_pk_bf16_f32 v116, v56, v57
    v_exp_f32 v60, v60
    v_exp_f32 v61, v61
    ds_read_b128 v[148:151], v185 offset:672
    v_cvt_pk_bf16_f32 v117, v58, v59
    v_exp_f32 v62, v62
    v_mfma_f32_32x32x16_bf16 v[16:31], v[128:131], v[168:171], v[16:31]
    v_exp_f32 v63, v63
    v_cvt_pk_bf16_f32 v118, v60, v61
    v_exp_f32 v64, v64
    v_cvt_pk_bf16_f32 v119, v62, v63
    v_exp_f32 v65, v65
    v_exp_f32 v66, v66
    v_mfma_f32_32x32x16_bf16 v[80:95], v[160:163], v[112:115], v[80:95]
    v_exp_f32 v67, v67
    v_cvt_pk_bf16_f32 v120, v64, v65
    v_exp_f32 v68, v68
    v_exp_f32 v69, v69
    v_cvt_pk_bf16_f32 v121, v66, v67
    v_exp_f32 v70, v70
    v_exp_f32 v71, v71
    v_mfma_f32_32x32x16_bf16 v[32:47], v[128:131], v[172:175], v[32:47]
    v_cvt_pk_bf16_f32 v122, v68, v69
    v_exp_f32 v72, v72
    v_exp_f32 v73, v73
    v_cvt_pk_bf16_f32 v123, v70, v71
    v_exp_f32 v74, v74
    v_exp_f32 v75, v75
    v_mfma_f32_32x32x16_bf16 v[80:95], v[164:167], v[116:119], v[80:95]
    v_cvt_pk_bf16_f32 v124, v72, v73
    v_exp_f32 v76, v76
    v_exp_f32 v77, v77
    v_cvt_pk_bf16_f32 v125, v74, v75
    v_exp_f32 v78, v78
    v_exp_f32 v79, v79
    v_cvt_pk_bf16_f32 v126, v76, v77
    s_waitcnt lgkmcnt(0)
    v_cvt_pk_bf16_f32 v127, v78, v79
    v_swap_b32 v180, v183
    v_swap_b32 v181, v184
    v_swap_b32 v182, v185
    s_mov_b32 s61, s86
    s_mov_b32 s86, s87
    s_mov_b32 s87, s61
    s_add_u32 s85, s85, 1
    s_max_u32 s61, s85, 3
    s_sub_u32 s61, s61, 3
    s_mul_i32 s62, s61, 5120
    s_add_u32 s75, s96, s62
    s_mul_i32 s62, s61, 40960
    s_add_u32 s76, s94, s62
    s_cmp_eq_u32 s85, s95
    s_cbranch_scc1 L_ev
    s_cmp_lt_u32 s85, 8
    s_cbranch_scc1 L_attn_loop
L_attn_done:
    s_nop 0
    v_mfma_f32_32x32x16_bf16 v[96:111], v[160:163], v[120:123], v[96:111]
    v_mfma_f32_32x32x16_bf16 v[96:111], v[164:167], v[124:127], v[96:111]
L_attn_fin:
    s_mul_i32 s61, s53, 2621440
    s_add_u32 s61, s61, 13631488
    s_lshl_b32 s62, s54, 2
    s_add_u32 s62, s62, s52
    s_mul_i32 s62, s62, 81920
    s_add_u32 s61, s61, s62
    s_lshr_b32 s62, s55, 1
    s_lshl_b32 s62, s62, 10
    s_and_b32 s63, s55, 1
    s_lshl_b32 s64, s63, 9
    s_add_u32 s62, s62, s64
    s_add_u32 s62, s62, s61
    s_lshr_b32 s64, s55, 3
    s_lshl_b32 s64, s64, 10
    s_bfe_u32 s65, s55, 0x20001
    s_lshl_b32 s65, s65, 7
    s_add_u32 s64, s64, s65
    s_lshl_b32 s63, s63, 9
    s_add_u32 s64, s64, s63
    s_add_u32 s64, s64, 16384
    s_add_u32 s64, s64, s61
    s_add_u32 s63, s62, 40960
    v_bfe_u32 v2, v0, 4, 1
    v_mul_u32_u24 v2, 20480, v2
    v_and_b32 v3, 15, v0
    v_lshl_add_u32 v5, v3, 3, v2
    v_lshl_add_u32 v2, v3, 4, v2
    v_lshrrev_b32 v3, 5, v0
    v_lshl_add_u32 v4, v3, 8, v2
    v_mul_u32_u24 v3, 40960, v3
    v_add_u32 v5, v3, v5
    s_mov_b32 s65, 0x21800000
    s_mov_b32 s66, 0x5d800000
    v_cmp_nge_f32 vcc, v92, s65
    v_cmp_nle_f32 s[70:71], v92, s66
    s_or_b64 vcc, vcc, s[70:71]
    v_cmp_nge_f32 s[70:71], v108, s65
    s_or_b64 vcc, vcc, s[70:71]
    v_cmp_nle_f32 s[70:71], v108, s66
    s_or_b64 vcc, vcc, s[70:71]
    s_cbranch_vccnz L_slow
L_slow_ret:
    v_rcp_f32 v6, v92
    v_rcp_f32 v8, v108
    s_nop 0
    v_pk_mul_f32 v[80:81], v[80:81], v[6:7] op_sel_hi:[1,0]
    v_pk_mul_f32 v[82:83], v[82:83], v[6:7] op_sel_hi:[1,0]
    v_pk_mul_f32 v[84:85], v[84:85], v[6:7] op_sel_hi:[1,0]
    v_pk_mul_f32 v[86:87], v[86:87], v[6:7] op_sel_hi:[1,0]
    v_pk_mul_f32 v[88:89], v[88:89], v[6:7] op_sel_hi:[1,0]
    v_pk_mul_f32 v[90:91], v[90:91], v[6:7] op_sel_hi:[1,0]
    v_cvt_pk_bf16_f32 v16, v80, v81
    v_cvt_pk_bf16_f32 v17, v82, v83
    v_cvt_pk_bf16_f32 v18, v84, v85
    v_cvt_pk_bf16_f32 v19, v86, v87
    v_cvt_pk_bf16_f32 v20, v88, v89
    v_cvt_pk_bf16_f32 v21, v90, v91
    v_pk_mul_f32 v[96:97], v[96:97], v[8:9] op_sel_hi:[1,0]
    v_pk_mul_f32 v[98:99], v[98:99], v[8:9] op_sel_hi:[1,0]
    v_pk_mul_f32 v[100:101], v[100:101], v[8:9] op_sel_hi:[1,0]
    v_pk_mul_f32 v[102:103], v[102:103], v[8:9] op_sel_hi:[1,0]
    v_pk_mul_f32 v[104:105], v[104:105], v[8:9] op_sel_hi:[1,0]
    v_pk_mul_f32 v[106:107], v[106:107], v[8:9] op_sel_hi:[1,0]
    v_cvt_pk_bf16_f32 v24, v96, v97
    v_cvt_pk_bf16_f32 v25, v98, v99
    v_cvt_pk_bf16_f32 v26, v100, v101
    v_cvt_pk_bf16_f32 v27, v102, v103
    v_cvt_pk_bf16_f32 v28, v104, v105
    v_cvt_pk_bf16_f32 v29, v106, v107
    buffer_store_dwordx4 v[16:19], v4, s[40:43], s62 offen sc1
    buffer_store_dwordx4 v[24:27], v4, s[40:43], s63 offen sc1
    v_permlane32_swap_b32 v20, v28
    v_permlane32_swap_b32 v21, v29
    buffer_store_dwordx2 v[20:21], v5, s[40:43], s64 offen sc1
    v_and_b32 v240, 31, v0
    v_lshlrev_b32 v240, 2, v240
    s_lshl_b32 s69, s53, 16
    s_add_u32 s69, s69, 36642816
    s_lshl_b32 s68, s54, 7
    s_add_u32 s69, s69, s68
    s_lshl_b32 s68, s100, 10
    s_add_u32 s69, s69, s68
    s_lshl_b32 s101, s53, 16
    s_add_u32 s101, s101, 36642816
    s_lshl_b32 s68, s54, 7
    s_add_u32 s101, s101, s68
    s_lshl_b32 s68, s55, 2
    s_add_u32 s101, s101, s68
    v_lshlrev_b32 v1, 10, v0
    s_waitcnt vmcnt(0)
    s_barrier
    s_cmp_lg_u32 s52, 0
    s_cbranch_scc1 W0_15
    s_mov_b64 exec, 255
    buffer_atomic_swap v243, v1, s[40:43], s101 offen sc1
    s_mov_b64 exec, -1
W0_15:
    s_cmp_eq_u32 s98, 0
    s_cbranch_scc1 NOW1_16
    v_lshrrev_b32 v2, 3, v0
    v_mul_u32_u24 v2, 3072, v2
    v_bfe_u32 v3, v0, 4, 1
    v_lshlrev_b32 v3, 2, v3
    v_and_b32 v4, 7, v0
    v_xor_b32 v3, v3, v4
    v_lshl_add_u32 v10, v3, 4, v2
    v_add_u32 v11, 23552, v10
    v_add_u32 v12, 47104, v10
    v_add_u32 v13, 70656, v10
    s_mul_i32 s66, s52, 1572864
    s_lshl_b32 s62, s59, 7
    s_add_u32 s66, s66, s62
    s_mul_i32 s96, s52, 15360
    s_add_u32 s96, s96, 102400
    v_lshrrev_b32 v3, 5, v0
    v_bfe_u32 v4, v0, 2, 2
    v_lshl_add_u32 v3, v3, 3, v4
    v_lshlrev_b32 v3, 7, v3
    v_add_u32 v3, s96, v3
    v_and_b32 v4, 1, v0
    v_lshl_add_u32 v3, v4, 3, v3
    v_bfe_u32 v4, v0, 1, 1
    v_lshl_add_u32 v3, v4, 4, v3
    v_bfe_u32 v4, v0, 4, 1
    v_lshl_add_u32 v3, v4, 5, v3
    v_bfe_u32 v4, v0, 3, 1
    s_lshr_b32 s63, s52, 1
    v_xor_b32 v4, s63, v4
    v_lshl_add_u32 v14, v4, 6, v3
    v_xor_b32 v4, 1, v4
    v_lshl_add_u32 v15, v4, 6, v3
    s_add_u32 m0, s96, 12288
    s_add_u32 s63, s66, 983040
    buffer_load_dwordx4 v10, s[16:19], s63 offen offset:0 lds
    buffer_load_dwordx4 v11, s[16:19], s63 offen offset:1024 lds
    s_add_u32 m0, s96, 0
    s_add_u32 s63, s66, 1032192
    buffer_load_dwordx4 v10, s[16:19], s63 offen offset:0 lds
    buffer_load_dwordx4 v11, s[16:19], s63 offen offset:1024 lds
    s_add_u32 m0, s96, 2048
    s_add_u32 s63, s66, 1081344
    buffer_load_dwordx4 v10, s[16:19], s63 offen offset:0 lds
    buffer_load_dwordx4 v11, s[16:19], s63 offen offset:1024 lds
    s_add_u32 m0, s96, 4096
    s_add_u32 s63, s66, 1130496
    buffer_load_dwordx4 v10, s[16:19], s63 offen offset:0 lds
    buffer_load_dwordx4 v11, s[16:19], s63 offen offset:1024 lds
    s_add_u32 m0, s96, 6144
    s_add_u32 s63, s66, 1179648
    buffer_load_dwordx4 v10, s[16:19], s63 offen offset:0 lds
    buffer_load_dwordx4 v11, s[16:19], s63 offen offset:1024 lds
    s_add_u32 m0, s96, 8192
    s_add_u32 s63, s66, 1228800
    buffer_load_dwordx4 v10, s[16:19], s63 offen offset:0 lds
    buffer_load_dwordx4 v11, s[16:19], s63 offen offset:1024 lds
    s_add_u32 m0, s96, 10240
    s_add_u32 s63, s66, 1277952
    buffer_load_dwordx4 v10, s[16:19], s63 offen offset:0 lds
    buffer_load_dwordx4 v11, s[16:19], s63 offen offset:1024 lds
    s_waitcnt vmcnt(12)
    ds_read_b64_tr_b16 a[160:161], v14 offset:12288
    ds_read_b64_tr_b16 a[162:163], v14 offset:12800
    ds_read_b64_tr_b16 a[164:165], v15 offset:12288
    ds_read_b64_tr_b16 a[166:167], v15 offset:12800
    s_waitcnt vmcnt(10)
    ds_read_b64_tr_b16 a[168:169], v14 offset:0
    ds_read_b64_tr_b16 a[170:171], v14 offset:512
    ds_read_b64_tr_b16 a[172:173], v15 offset:0
    ds_read_b64_tr_b16 a[174:175], v15 offset:512
    s_waitcnt lgkmcnt(4)
    s_add_u32 m0, s96, 12288
    s_add_u32 s63, s66, 1327104
    buffer_load_dwordx4 v10, s[16:19], s63 offen offset:0 lds
    buffer_load_dwordx4 v11, s[16:19], s63 offen offset:1024 lds
    s_waitcnt vmcnt(10)
    ds_read_b64_tr_b16 a[176:177], v14 offset:2048
    ds_read_b64_tr_b16 a[178:179], v14 offset:2560
    ds_read_b64_tr_b16 a[180:181], v15 offset:2048
    ds_read_b64_tr_b16 a[182:183], v15 offset:2560
    s_waitcnt lgkmcnt(4)
    s_add_u32 m0, s96, 0
    s_add_u32 s63, s66, 1376256
    buffer_load_dwordx4 v10, s[16:19], s63 offen offset:0 lds
    buffer_load_dwordx4 v11, s[16:19], s63 offen offset:1024 lds
    s_waitcnt vmcnt(10)
    ds_read_b64_tr_b16 a[184:185], v14 offset:4096
    ds_read_b64_tr_b16 a[186:187], v14 offset:4608
    ds_read_b64_tr_b16 a[188:189], v15 offset:4096
    ds_read_b64_tr_b16 a[190:191], v15 offset:4608
    s_waitcnt lgkmcnt(4)
    s_add_u32 m0, s96, 2048
    s_add_u32 s63, s66, 1425408
    buffer_load_dwordx4 v10, s[16:19], s63 offen offset:0 lds
    buffer_load_dwordx4 v11, s[16:19], s63 offen offset:1024 lds
    s_waitcnt vmcnt(10)
    ds_read_b64_tr_b16 a[192:193], v14 offset:6144
    ds_read_b64_tr_b16 a[194:195], v14 offset:6656
    ds_read_b64_tr_b16 a[196:197], v15 offset:6144
    ds_read_b64_tr_b16 a[198:199], v15 offset:6656
    s_waitcnt lgkmcnt(4)
    s_add_u32 m0, s96, 4096
    s_add_u32 s63, s66, 1474560
    buffer_load_dwordx4 v10, s[16:19], s63 offen offset:0 lds
    buffer_load_dwordx4 v11, s[16:19], s63 offen offset:1024 lds
    s_waitcnt vmcnt(10)
    ds_read_b64_tr_b16 a[200:201], v14 offset:8192
    ds_read_b64_tr_b16 a[202:203], v14 offset:8704
    ds_read_b64_tr_b16 a[204:205], v15 offset:8192
    ds_read_b64_tr_b16 a[206:207], v15 offset:8704
    s_waitcnt lgkmcnt(4)
    s_add_u32 m0, s96, 6144
    s_add_u32 s63, s66, 1523712
    buffer_load_dwordx4 v10, s[16:19], s63 offen offset:0 lds
    buffer_load_dwordx4 v11, s[16:19], s63 offen offset:1024 lds
    s_waitcnt vmcnt(10)
    ds_read_b64_tr_b16 a[208:209], v14 offset:10240
    ds_read_b64_tr_b16 a[210:211], v14 offset:10752
    ds_read_b64_tr_b16 a[212:213], v15 offset:10240
    ds_read_b64_tr_b16 a[214:215], v15 offset:10752
    s_waitcnt vmcnt(8)
    ds_read_b64_tr_b16 a[216:217], v14 offset:12288
    ds_read_b64_tr_b16 a[218:219], v14 offset:12800
    ds_read_b64_tr_b16 a[220:221], v15 offset:12288
    ds_read_b64_tr_b16 a[222:223], v15 offset:12800
    s_waitcnt vmcnt(6)
    ds_read_b64_tr_b16 a[224:225], v14 offset:0
    ds_read_b64_tr_b16 a[226:227], v14 offset:512
    ds_read_b64_tr_b16 a[228:229], v15 offset:0
    ds_read_b64_tr_b16 a[230:231], v15 offset:512
    s_waitcnt vmcnt(4)
    ds_read_b64_tr_b16 a[232:233], v14 offset:2048
    ds_read_b64_tr_b16 a[234:235], v14 offset:2560
    ds_read_b64_tr_b16 a[236:237], v15 offset:2048
    ds_read_b64_tr_b16 a[238:239], v15 offset:2560
    s_waitcnt vmcnt(2)
    ds_read_b64_tr_b16 a[240:241], v14 offset:4096
    ds_read_b64_tr_b16 a[242:243], v14 offset:4608
    ds_read_b64_tr_b16 a[244:245], v15 offset:4096
    ds_read_b64_tr_b16 a[246:247], v15 offset:4608
    s_waitcnt vmcnt(0)
    ds_read_b64_tr_b16 a[248:249], v14 offset:6144
    ds_read_b64_tr_b16 a[250:251], v14 offset:6656
    ds_read_b64_tr_b16 a[252:253], v15 offset:6144
    ds_read_b64_tr_b16 a[254:255], v15 offset:6656
NOW1_16:
    v_lshrrev_b32 v2, 5, v0
    v_mul_u32_u24 v2, 20, v2
    v_bfe_u32 v3, v0, 2, 3
    v_add_u32 v2, v2, v3
    v_mul_u32_u24 v2, 160, v2
    v_and_b32 v8, 3, v0
    v_lshl_add_u32 v4, v8, 3, v2
    v_add_u32 v5, 51200, v4
    v_lshrrev_b32 v2, 4, v0
    v_mul_u32_u24 v2, 40, v2
    v_bfe_u32 v3, v0, 2, 2
    v_add3_u32 v2, v2, v3, 16
    v_mul_u32_u24 v2, 160, v2
    v_lshl_add_u32 v6, v8, 3, v2
    v_add_u32 v7, 51200, v6
    ds_read_b64_tr_b16 v[120:121], v4 offset:0
    ds_read_b64_tr_b16 v[122:123], v4 offset:1280
    ds_read_b64_tr_b16 v[124:125], v4 offset:32
    ds_read_b64_tr_b16 v[126:127], v4 offset:1312
    ds_read_b64_tr_b16 v[128:129], v4 offset:64
    ds_read_b64_tr_b16 v[130:131], v4 offset:1344
    ds_read_b64_tr_b16 v[132:133], v4 offset:96
    ds_read_b64_tr_b16 v[134:135], v4 offset:1376
    ds_read_b64_tr_b16 v[136:137], v4 offset:128
    ds_read_b64_tr_b16 v[138:139], v4 offset:1408
    ds_read_b64_tr_b16 v[140:141], v4 offset:6400
    ds_read_b64_tr_b16 v[142:143], v4 offset:7680
    ds_read_b64_tr_b16 v[144:145], v4 offset:6432
    ds_read_b64_tr_b16 v[146:147], v4 offset:7712
    ds_read_b64_tr_b16 v[148:149], v4 offset:6464
    ds_read_b64_tr_b16 v[150:151], v4 offset:7744
    ds_read_b64_tr_b16 v[152:153], v4 offset:6496
    ds_read_b64_tr_b16 v[154:155], v4 offset:7776
    ds_read_b64_tr_b16 v[156:157], v4 offset:6528
    ds_read_b64_tr_b16 v[158:159], v4 offset:7808
    ds_read_b64_tr_b16 v[160:161], v4 offset:12800
    ds_read_b64_tr_b16 v[162:163], v4 offset:14080
    ds_read_b64_tr_b16 v[164:165], v4 offset:12832
    ds_read_b64_tr_b16 v[166:167], v4 offset:14112
    ds_read_b64_tr_b16 v[168:169], v4 offset:12864
    ds_read_b64_tr_b16 v[170:171], v4 offset:14144
    ds_read_b64_tr_b16 v[172:173], v4 offset:12896
    ds_read_b64_tr_b16 v[174:175], v4 offset:14176
    ds_read_b64_tr_b16 v[176:177], v4 offset:12928
    ds_read_b64_tr_b16 v[178:179], v4 offset:14208
    ds_read_b64_tr_b16 v[180:181], v4 offset:19200
    ds_read_b64_tr_b16 v[182:183], v4 offset:20480
    ds_read_b64_tr_b16 v[184:185], v4 offset:19232
    ds_read_b64_tr_b16 v[186:187], v4 offset:20512
    ds_read_b64_tr_b16 v[188:189], v4 offset:19264
    ds_read_b64_tr_b16 v[190:191], v4 offset:20544
    ds_read_b64_tr_b16 v[192:193], v4 offset:19296
    ds_read_b64_tr_b16 v[194:195], v4 offset:20576
    ds_read_b64_tr_b16 v[196:197], v4 offset:19328
    ds_read_b64_tr_b16 v[198:199], v4 offset:20608
    ds_read_b64_tr_b16 v[200:201], v4 offset:25600
    ds_read_b64_tr_b16 v[202:203], v4 offset:26880
    ds_read_b64_tr_b16 v[204:205], v4 offset:25632
    ds_read_b64_tr_b16 v[206:207], v4 offset:26912
    ds_read_b64_tr_b16 v[208:209], v4 offset:25664
    ds_read_b64_tr_b16 v[210:211], v4 offset:26944
    ds_read_b64_tr_b16 v[212:213], v4 offset:25696
    ds_read_b64_tr_b16 v[214:215], v4 offset:26976
    ds_read_b64_tr_b16 v[216:217], v4 offset:25728
    ds_read_b64_tr_b16 v[218:219], v4 offset:27008
    ds_read_b64_tr_b16 v[220:221], v4 offset:32000
    ds_read_b64_tr_b16 v[222:223], v4 offset:33280
    ds_read_b64_tr_b16 v[224:225], v4 offset:32032
    ds_read_b64_tr_b16 v[226:227], v4 offset:33312
    ds_read_b64_tr_b16 v[228:229], v4 offset:32064
    ds_read_b64_tr_b16 v[230:231], v4 offset:33344
    ds_read_b64_tr_b16 v[232:233], v4 offset:32096
    ds_read_b64_tr_b16 v[234:235], v4 offset:33376
    ds_read_b64_tr_b16 v[236:237], v4 offset:32128
    ds_read_b64_tr_b16 v[238:239], v4 offset:33408
    s_mul_i32 s61, s53, 2621440
    s_add_u32 s61, s61, 13631488
    s_lshl_b32 s62, s56, 2
    s_add_u32 s62, s62, s52
    s_mul_i32 s62, s62, 20480
    s_add_u32 s61, s61, s62
    v_lshlrev_b32 v2, 4, v0
    v_lshlrev_b32 v3, 3, v0
    s_cmp_lg_u32 s52, 0
    s_cbranch_scc1 W0_17
    s_mov_b32 s82, 4194304
FW_18:
    buffer_load_dword v1, v240, s[40:43], s69 offen sc1
    s_sub_u32 s82, s82, 1
    s_cbranch_scc1 L_exit
    s_waitcnt vmcnt(0)
    v_cmp_ne_u32 vcc, s99, v1
    s_cbranch_vccnz FW_18
W0_17:
    s_barrier
    buffer_load_dwordx4 v[40:43], v2, s[40:43], s61 offen offset:0
    buffer_load_dwordx4 v[44:47], v2, s[40:43], s61 offen offset:1024
    buffer_load_dwordx4 v[48:51], v2, s[40:43], s61 offen offset:2048
    buffer_load_dwordx4 v[52:55], v2, s[40:43], s61 offen offset:3072
    s_add_u32 s61, s61, 4096
    buffer_load_dwordx4 v[56:59], v2, s[40:43], s61 offen offset:0
    buffer_load_dwordx4 v[60:63], v2, s[40:43], s61 offen offset:1024
    buffer_load_dwordx4 v[64:67], v2, s[40:43], s61 offen offset:2048
    buffer_load_dwordx4 v[68:71], v2, s[40:43], s61 offen offset:3072
    s_add_u32 s61, s61, 4096
    buffer_load_dwordx4 v[72:75], v2, s[40:43], s61 offen offset:0
    buffer_load_dwordx4 v[76:79], v2, s[40:43], s61 offen offset:1024
    buffer_load_dwordx4 v[80:83], v2, s[40:43], s61 offen offset:2048
    buffer_load_dwordx4 v[84:87], v2, s[40:43], s61 offen offset:3072
    s_add_u32 s61, s61, 4096
    buffer_load_dwordx4 v[88:91], v2, s[40:43], s61 offen offset:0
    buffer_load_dwordx4 v[92:95], v2, s[40:43], s61 offen offset:1024
    buffer_load_dwordx4 v[96:99], v2, s[40:43], s61 offen offset:2048
    buffer_load_dwordx4 v[100:103], v2, s[40:43], s61 offen offset:3072
    s_add_u32 s61, s61, 4096
    buffer_load_dwordx2 v[104:105], v3, s[40:43], s61 offen offset:0
    buffer_load_dwordx2 v[106:107], v3, s[40:43], s61 offen offset:512
    buffer_load_dwordx2 v[108:109], v3, s[40:43], s61 offen offset:1024
    buffer_load_dwordx2 v[110:111], v3, s[40:43], s61 offen offset:1536
    buffer_load_dwordx2 v[112:113], v3, s[40:43], s61 offen offset:2048
    buffer_load_dwordx2 v[114:115], v3, s[40:43], s61 offen offset:2560
    buffer_load_dwordx2 v[116:117], v3, s[40:43], s61 offen offset:3072
    buffer_load_dwordx2 v[118:119], v3, s[40:43], s61 offen offset:3584
    s_add_u32 s61, s61, 4096
    s_waitcnt lgkmcnt(0)
    s_waitcnt vmcnt(23)
    v_mfma_f32_16x16x32_bf16 v[16:19], v[120:123], v[40:43], 0
    v_mfma_f32_16x16x32_bf16 v[20:23], v[124:127], v[40:43], 0
    v_mfma_f32_16x16x32_bf16 v[24:27], v[128:131], v[40:43], 0
    v_mfma_f32_16x16x32_bf16 v[28:31], v[132:135], v[40:43], 0
    v_mfma_f32_16x16x32_bf16 v[32:35], v[136:139], v[40:43], 0
    ds_read_b64_tr_b16 v[120:121], v4 offset:38400
    ds_read_b64_tr_b16 v[122:123], v4 offset:39680
    ds_read_b64_tr_b16 v[124:125], v4 offset:38432
    ds_read_b64_tr_b16 v[126:127], v4 offset:39712
    ds_read_b64_tr_b16 v[128:129], v4 offset:38464
    ds_read_b64_tr_b16 v[130:131], v4 offset:39744
    ds_read_b64_tr_b16 v[132:133], v4 offset:38496
    ds_read_b64_tr_b16 v[134:135], v4 offset:39776
    ds_read_b64_tr_b16 v[136:137], v4 offset:38528
    ds_read_b64_tr_b16 v[138:139], v4 offset:39808
    s_waitcnt vmcnt(22)
    v_mfma_f32_16x16x32_bf16 v[16:19], v[140:143], v[44:47], v[16:19]
    v_mfma_f32_16x16x32_bf16 v[20:23], v[144:147], v[44:47], v[20:23]
    v_mfma_f32_16x16x32_bf16 v[24:27], v[148:151], v[44:47], v[24:27]
    v_mfma_f32_16x16x32_bf16 v[28:31], v[152:155], v[44:47], v[28:31]
    v_mfma_f32_16x16x32_bf16 v[32:35], v[156:159], v[44:47], v[32:35]
    ds_read_b64_tr_b16 v[140:141], v4 offset:44800
    ds_read_b64_tr_b16 v[142:143], v4 offset:46080
    ds_read_b64_tr_b16 v[144:145], v4 offset:44832
    ds_read_b64_tr_b16 v[146:147], v4 offset:46112
    ds_read_b64_tr_b16 v[148:149], v4 offset:44864
    ds_read_b64_tr_b16 v[150:151], v4 offset:46144
    ds_read_b64_tr_b16 v[152:153], v4 offset:44896
    ds_read_b64_tr_b16 v[154:155], v4 offset:46176
    ds_read_b64_tr_b16 v[156:157], v4 offset:44928
    ds_read_b64_tr_b16 v[158:159], v4 offset:46208
    s_waitcnt vmcnt(21)
    v_mfma_f32_16x16x32_bf16 v[16:19], v[160:163], v[48:51], v[16:19]
    v_mfma_f32_16x16x32_bf16 v[20:23], v[164:167], v[48:51], v[20:23]
    v_mfma_f32_16x16x32_bf16 v[24:27], v[168:171], v[48:51], v[24:27]
    v_mfma_f32_16x16x32_bf16 v[28:31], v[172:175], v[48:51], v[28:31]
    v_mfma_f32_16x16x32_bf16 v[32:35], v[176:179], v[48:51], v[32:35]
    ds_read_b64_tr_b16 v[160:161], v5 offset:0
    ds_read_b64_tr_b16 v[162:163], v5 offset:1280
    ds_read_b64_tr_b16 v[164:165], v5 offset:32
    ds_read_b64_tr_b16 v[166:167], v5 offset:1312
    ds_read_b64_tr_b16 v[168:169], v5 offset:64
    ds_read_b64_tr_b16 v[170:171], v5 offset:1344
    ds_read_b64_tr_b16 v[172:173], v5 offset:96
    ds_read_b64_tr_b16 v[174:175], v5 offset:1376
    ds_read_b64_tr_b16 v[176:177], v5 offset:128
    ds_read_b64_tr_b16 v[178:179], v5 offset:1408
    s_waitcnt vmcnt(20)
    v_mfma_f32_16x16x32_bf16 v[16:19], v[180:183], v[52:55], v[16:19]
    v_mfma_f32_16x16x32_bf16 v[20:23], v[184:187], v[52:55], v[20:23]
    v_mfma_f32_16x16x32_bf16 v[24:27], v[188:191], v[52:55], v[24:27]
    v_mfma_f32_16x16x32_bf16 v[28:31], v[192:195], v[52:55], v[28:31]
    v_mfma_f32_16x16x32_bf16 v[32:35], v[196:199], v[52:55], v[32:35]
    ds_read_b64_tr_b16 v[180:181], v5 offset:6400
    ds_read_b64_tr_b16 v[182:183], v5 offset:7680
    ds_read_b64_tr_b16 v[184:185], v5 offset:6432
    ds_read_b64_tr_b16 v[186:187], v5 offset:7712
    ds_read_b64_tr_b16 v[188:189], v5 offset:6464
    ds_read_b64_tr_b16 v[190:191], v5 offset:7744
    ds_read_b64_tr_b16 v[192:193], v5 offset:6496
    ds_read_b64_tr_b16 v[194:195], v5 offset:7776
    ds_read_b64_tr_b16 v[196:197], v5 offset:6528
    ds_read_b64_tr_b16 v[198:199], v5 offset:7808
    s_waitcnt vmcnt(19)
    v_mfma_f32_16x16x32_bf16 v[16:19], v[200:203], v[56:59], v[16:19]
    v_mfma_f32_16x16x32_bf16 v[20:23], v[204:207], v[56:59], v[20:23]
    v_mfma_f32_16x16x32_bf16 v[24:27], v[208:211], v[56:59], v[24:27]
    v_mfma_f32_16x16x32_bf16 v[28:31], v[212:215], v[56:59], v[28:31]
    v_mfma_f32_16x16x32_bf16 v[32:35], v[216:219], v[56:59], v[32:35]
    ds_read_b64_tr_b16 v[200:201], v5 offset:12800
    ds_read_b64_tr_b16 v[202:203], v5 offset:14080
    ds_read_b64_tr_b16 v[204:205], v5 offset:12832
    ds_read_b64_tr_b16 v[206:207], v5 offset:14112
    ds_read_b64_tr_b16 v[208:209], v5 offset:12864
    ds_read_b64_tr_b16 v[210:211], v5 offset:14144
    ds_read_b64_tr_b16 v[212:213], v5 offset:12896
    ds_read_b64_tr_b16 v[214:215], v5 offset:14176
    ds_read_b64_tr_b16 v[216:217], v5 offset:12928
    ds_read_b64_tr_b16 v[218:219], v5 offset:14208
    s_waitcnt vmcnt(18)
    v_mfma_f32_16x16x32_bf16 v[16:19], v[220:223], v[60:63], v[16:19]
    v_mfma_f32_16x16x32_bf16 v[20:23], v[224:227], v[60:63], v[20:23]
    v_mfma_f32_16x16x32_bf16 v[24:27], v[228:231], v[60:63], v[24:27]
    v_mfma_f32_16x16x32_bf16 v[28:31], v[232:235], v[60:63], v[28:31]
    v_mfma_f32_16x16x32_bf16 v[32:35], v[236:239], v[60:63], v[32:35]
    ds_read_b64_tr_b16 v[220:221], v5 offset:19200
    ds_read_b64_tr_b16 v[222:223], v5 offset:20480
    ds_read_b64_tr_b16 v[224:225], v5 offset:19232
    ds_read_b64_tr_b16 v[226:227], v5 offset:20512
    ds_read_b64_tr_b16 v[228:229], v5 offset:19264
    ds_read_b64_tr_b16 v[230:231], v5 offset:20544
    ds_read_b64_tr_b16 v[232:233], v5 offset:19296
    ds_read_b64_tr_b16 v[234:235], v5 offset:20576
    ds_read_b64_tr_b16 v[236:237], v5 offset:19328
    ds_read_b64_tr_b16 v[238:239], v5 offset:20608
    s_waitcnt vmcnt(17)
    s_waitcnt lgkmcnt(10)
    v_mfma_f32_16x16x32_bf16 v[16:19], v[120:123], v[64:67], v[16:19]
    v_mfma_f32_16x16x32_bf16 v[20:23], v[124:127], v[64:67], v[20:23]
    v_mfma_f32_16x16x32_bf16 v[24:27], v[128:131], v[64:67], v[24:27]
    v_mfma_f32_16x16x32_bf16 v[28:31], v[132:135], v[64:67], v[28:31]
    v_mfma_f32_16x16x32_bf16 v[32:35], v[136:139], v[64:67], v[32:35]
    ds_read_b64_tr_b16 v[120:121], v5 offset:25600
    ds_read_b64_tr_b16 v[122:123], v5 offset:26880
    ds_read_b64_tr_b16 v[124:125], v5 offset:25632
    ds_read_b64_tr_b16 v[126:127], v5 offset:26912
    ds_read_b64_tr_b16 v[128:129], v5 offset:25664
    ds_read_b64_tr_b16 v[130:131], v5 offset:26944
    ds_read_b64_tr_b16 v[132:133], v5 offset:25696
    ds_read_b64_tr_b16 v[134:135], v5 offset:26976
    ds_read_b64_tr_b16 v[136:137], v5 offset:25728
    ds_read_b64_tr_b16 v[138:139], v5 offset:27008
    s_waitcnt vmcnt(16)
    s_waitcnt lgkmcnt(10)
    v_mfma_f32_16x16x32_bf16 v[16:19], v[140:143], v[68:71], v[16:19]
    v_mfma_f32_16x16x32_bf16 v[20:23], v[144:147], v[68:71], v[20:23]
    v_mfma_f32_16x16x32_bf16 v[24:27], v[148:151], v[68:71], v[24:27]
    v_mfma_f32_16x16x32_bf16 v[28:31], v[152:155], v[68:71], v[28:31]
    v_mfma_f32_16x16x32_bf16 v[32:35], v[156:159], v[68:71], v[32:35]
    ds_read_b64_tr_b16 v[140:141], v5 offset:32000
    ds_read_b64_tr_b16 v[142:143], v5 offset:33280
    ds_read_b64_tr_b16 v[144:145], v5 offset:32032
    ds_read_b64_tr_b16 v[146:147], v5 offset:33312
    ds_read_b64_tr_b16 v[148:149], v5 offset:32064
    ds_read_b64_tr_b16 v[150:151], v5 offset:33344
    ds_read_b64_tr_b16 v[152:153], v5 offset:32096
    ds_read_b64_tr_b16 v[154:155], v5 offset:33376
    ds_read_b64_tr_b16 v[156:157], v5 offset:32128
    ds_read_b64_tr_b16 v[158:159], v5 offset:33408
    s_waitcnt vmcnt(15)
    s_waitcnt lgkmcnt(10)
    v_mfma_f32_16x16x32_bf16 v[16:19], v[160:163], v[72:75], v[16:19]
    v_mfma_f32_16x16x32_bf16 v[20:23], v[164:167], v[72:75], v[20:23]
    v_mfma_f32_16x16x32_bf16 v[24:27], v[168:171], v[72:75], v[24:27]
    v_mfma_f32_16x16x32_bf16 v[28:31], v[172:175], v[72:75], v[28:31]
    v_mfma_f32_16x16x32_bf16 v[32:35], v[176:179], v[72:75], v[32:35]
    ds_read_b64_tr_b16 v[160:161], v5 offset:38400
    ds_read_b64_tr_b16 v[162:163], v5 offset:39680
    ds_read_b64_tr_b16 v[164:165], v5 offset:38432
    ds_read_b64_tr_b16 v[166:167], v5 offset:39712
    ds_read_b64_tr_b16 v[168:169], v5 offset:38464
    ds_read_b64_tr_b16 v[170:171], v5 offset:39744
    ds_read_b64_tr_b16 v[172:173], v5 offset:38496
    ds_read_b64_tr_b16 v[174:175], v5 offset:39776
    ds_read_b64_tr_b16 v[176:177], v5 offset:38528
    ds_read_b64_tr_b16 v[178:179], v5 offset:39808
    s_waitcnt vmcnt(14)
    s_waitcnt lgkmcnt(10)
    v_mfma_f32_16x16x32_bf16 v[16:19], v[180:183], v[76:79], v[16:19]
    v_mfma_f32_16x16x32_bf16 v[20:23], v[184:187], v[76:79], v[20:23]
    v_mfma_f32_16x16x32_bf16 v[24:27], v[188:191], v[76:79], v[24:27]
    v_mfma_f32_16x16x32_bf16 v[28:31], v[192:195], v[76:79], v[28:31]
    v_mfma_f32_16x16x32_bf16 v[32:35], v[196:199], v[76:79], v[32:35]
    ds_read_b64_tr_b16 v[180:181], v5 offset:44800
    ds_read_b64_tr_b16 v[182:183], v5 offset:46080
    ds_read_b64_tr_b16 v[184:185], v5 offset:44832
    ds_read_b64_tr_b16 v[186:187], v5 offset:46112
    ds_read_b64_tr_b16 v[188:189], v5 offset:44864
    ds_read_b64_tr_b16 v[190:191], v5 offset:46144
    ds_read_b64_tr_b16 v[192:193], v5 offset:44896
    ds_read_b64_tr_b16 v[194:195], v5 offset:46176
    ds_read_b64_tr_b16 v[196:197], v5 offset:44928
    ds_read_b64_tr_b16 v[198:199], v5 offset:46208
    s_waitcnt vmcnt(13)
    s_waitcnt lgkmcnt(10)
    v_mfma_f32_16x16x32_bf16 v[16:19], v[200:203], v[80:83], v[16:19]
    v_mfma_f32_16x16x32_bf16 v[20:23], v[204:207], v[80:83], v[20:23]
    v_mfma_f32_16x16x32_bf16 v[24:27], v[208:211], v[80:83], v[24:27]
    v_mfma_f32_16x16x32_bf16 v[28:31], v[212:215], v[80:83], v[28:31]
    v_mfma_f32_16x16x32_bf16 v[32:35], v[216:219], v[80:83], v[32:35]
    ds_read_b64_tr_b16 v[200:201], v6 offset:0
    ds_read_b64_tr_b16 v[202:203], v6 offset:3200
    ds_read_b64_tr_b16 v[204:205], v6 offset:32
    ds_read_b64_tr_b16 v[206:207], v6 offset:3232
    ds_read_b64_tr_b16 v[208:209], v6 offset:64
    ds_read_b64_tr_b16 v[210:211], v6 offset:3264
    ds_read_b64_tr_b16 v[212:213], v6 offset:96
    ds_read_b64_tr_b16 v[214:215], v6 offset:3296
    ds_read_b64_tr_b16 v[216:217], v6 offset:128
    ds_read_b64_tr_b16 v[218:219], v6 offset:3328
    s_waitcnt vmcnt(12)
    s_waitcnt lgkmcnt(10)
    v_mfma_f32_16x16x32_bf16 v[16:19], v[220:223], v[84:87], v[16:19]
    v_mfma_f32_16x16x32_bf16 v[20:23], v[224:227], v[84:87], v[20:23]
    v_mfma_f32_16x16x32_bf16 v[24:27], v[228:231], v[84:87], v[24:27]
    v_mfma_f32_16x16x32_bf16 v[28:31], v[232:235], v[84:87], v[28:31]
    v_mfma_f32_16x16x32_bf16 v[32:35], v[236:239], v[84:87], v[32:35]
    ds_read_b64_tr_b16 v[220:221], v6 offset:25600
    ds_read_b64_tr_b16 v[222:223], v6 offset:28800
    ds_read_b64_tr_b16 v[224:225], v6 offset:25632
    ds_read_b64_tr_b16 v[226:227], v6 offset:28832
    ds_read_b64_tr_b16 v[228:229], v6 offset:25664
    ds_read_b64_tr_b16 v[230:231], v6 offset:28864
    ds_read_b64_tr_b16 v[232:233], v6 offset:25696
    ds_read_b64_tr_b16 v[234:235], v6 offset:28896
    ds_read_b64_tr_b16 v[236:237], v6 offset:25728
    ds_read_b64_tr_b16 v[238:239], v6 offset:28928
    s_waitcnt vmcnt(11)
    s_waitcnt lgkmcnt(10)
    v_mfma_f32_16x16x32_bf16 v[16:19], v[120:123], v[88:91], v[16:19]
    v_mfma_f32_16x16x32_bf16 v[20:23], v[124:127], v[88:91], v[20:23]
    v_mfma_f32_16x16x32_bf16 v[24:27], v[128:131], v[88:91], v[24:27]
    v_mfma_f32_16x16x32_bf16 v[28:31], v[132:135], v[88:91], v[28:31]
    v_mfma_f32_16x16x32_bf16 v[32:35], v[136:139], v[88:91], v[32:35]
    ds_read_b64_tr_b16 v[120:121], v7 offset:0
    ds_read_b64_tr_b16 v[122:123], v7 offset:3200
    ds_read_b64_tr_b16 v[124:125], v7 offset:32
    ds_read_b64_tr_b16 v[126:127], v7 offset:3232
    ds_read_b64_tr_b16 v[128:129], v7 offset:64
    ds_read_b64_tr_b16 v[130:131], v7 offset:3264
    ds_read_b64_tr_b16 v[132:133], v7 offset:96
    ds_read_b64_tr_b16 v[134:135], v7 offset:3296
    ds_read_b64_tr_b16 v[136:137], v7 offset:128
    ds_read_b64_tr_b16 v[138:139], v7 offset:3328
    s_waitcnt vmcnt(10)
    s_waitcnt lgkmcnt(10)
    v_mfma_f32_16x16x32_bf16 v[16:19], v[140:143], v[92:95], v[16:19]
    v_mfma_f32_16x16x32_bf16 v[20:23], v[144:147], v[92:95], v[20:23]
    v_mfma_f32_16x16x32_bf16 v[24:27], v[148:151], v[92:95], v[24:27]
    v_mfma_f32_16x16x32_bf16 v[28:31], v[152:155], v[92:95], v[28:31]
    v_mfma_f32_16x16x32_bf16 v[32:35], v[156:159], v[92:95], v[32:35]
    ds_read_b64_tr_b16 v[140:141], v7 offset:25600
    ds_read_b64_tr_b16 v[142:143], v7 offset:28800
    ds_read_b64_tr_b16 v[144:145], v7 offset:25632
    ds_read_b64_tr_b16 v[146:147], v7 offset:28832
    ds_read_b64_tr_b16 v[148:149], v7 offset:25664
    ds_read_b64_tr_b16 v[150:151], v7 offset:28864
    ds_read_b64_tr_b16 v[152:153], v7 offset:25696
    ds_read_b64_tr_b16 v[154:155], v7 offset:28896
    ds_read_b64_tr_b16 v[156:157], v7 offset:25728
    ds_read_b64_tr_b16 v[158:159], v7 offset:28928
    s_waitcnt vmcnt(9)
    s_waitcnt lgkmcnt(10)
    v_mfma_f32_16x16x32_bf16 v[16:19], v[160:163], v[96:99], v[16:19]
    v_mfma_f32_16x16x32_bf16 v[20:23], v[164:167], v[96:99], v[20:23]
    v_mfma_f32_16x16x32_bf16 v[24:27], v[168:171], v[96:99], v[24:27]
    v_mfma_f32_16x16x32_bf16 v[28:31], v[172:175], v[96:99], v[28:31]
    v_mfma_f32_16x16x32_bf16 v[32:35], v[176:179], v[96:99], v[32:35]
    s_waitcnt vmcnt(8)
    s_waitcnt lgkmcnt(0)
    v_mfma_f32_16x16x32_bf16 v[16:19], v[180:183], v[100:103], v[16:19]
    v_mfma_f32_16x16x32_bf16 v[20:23], v[184:187], v[100:103], v[20:23]
    v_mfma_f32_16x16x32_bf16 v[24:27], v[188:191], v[100:103], v[24:27]
    v_mfma_f32_16x16x32_bf16 v[28:31], v[192:195], v[100:103], v[28:31]
    v_mfma_f32_16x16x32_bf16 v[32:35], v[196:199], v[100:103], v[32:35]
    s_waitcnt vmcnt(6)
    s_waitcnt lgkmcnt(0)
    v_mfma_f32_16x16x32_bf16 v[16:19], v[200:203], v[104:107], v[16:19]
    v_mfma_f32_16x16x32_bf16 v[20:23], v[204:207], v[104:107], v[20:23]
    v_mfma_f32_16x16x32_bf16 v[24:27], v[208:211], v[104:107], v[24:27]
    v_mfma_f32_16x16x32_bf16 v[28:31], v[212:215], v[104:107], v[28:31]
    v_mfma_f32_16x16x32_bf16 v[32:35], v[216:219], v[104:107], v[32:35]
    s_waitcnt vmcnt(4)
    s_waitcnt lgkmcnt(0)
    v_mfma_f32_16x16x32_bf16 v[16:19], v[220:223], v[108:111], v[16:19]
    v_mfma_f32_16x16x32_bf16 v[20:23], v[224:227], v[108:111], v[20:23]
    v_mfma_f32_16x16x32_bf16 v[24:27], v[228:231], v[108:111], v[24:27]
    v_mfma_f32_16x16x32_bf16 v[28:31], v[232:235], v[108:111], v[28:31]
    v_mfma_f32_16x16x32_bf16 v[32:35], v[236:239], v[108:111], v[32:35]
    s_waitcnt vmcnt(2)
    s_waitcnt lgkmcnt(0)
    v_mfma_f32_16x16x32_bf16 v[16:19], v[120:123], v[112:115], v[16:19]
    v_mfma_f32_16x16x32_bf16 v[20:23], v[124:127], v[112:115], v[20:23]
    v_mfma_f32_16x16x32_bf16 v[24:27], v[128:131], v[112:115], v[24:27]
    v_mfma_f32_16x16x32_bf16 v[28:31], v[132:135], v[112:115], v[28:31]
    v_mfma_f32_16x16x32_bf16 v[32:35], v[136:139], v[112:115], v[32:35]
    s_waitcnt vmcnt(0)
    s_waitcnt lgkmcnt(0)
    v_mfma_f32_16x16x32_bf16 v[16:19], v[140:143], v[116:119], v[16:19]
    v_mfma_f32_16x16x32_bf16 v[20:23], v[144:147], v[116:119], v[20:23]
    v_mfma_f32_16x16x32_bf16 v[24:27], v[148:151], v[116:119], v[24:27]
    v_mfma_f32_16x16x32_bf16 v[28:31], v[152:155], v[116:119], v[28:31]
    v_mfma_f32_16x16x32_bf16 v[32:35], v[156:159], v[116:119], v[32:35]
    s_barrier
    v_lshrrev_b32 v2, 3, v0
    v_lshlrev_b32 v2, 12, v2
    v_bfe_u32 v3, v0, 4, 2
    v_lshlrev_b32 v3, 1, v3
    v_and_b32 v4, 7, v0
    v_xor_b32 v3, v3, v4
    v_lshl_add_u32 v228, v3, 4, v2
    s_mov_b32 s61, 0xffff0000
    v_lshlrev_b32 v40, 16, v246
    v_and_b32 v41, s61, v246
    v_lshlrev_b32 v42, 16, v247
    v_and_b32 v43, s61, v247
    v_lshlrev_b32 v44, 16, v248
    v_and_b32 v45, s61, v248
    v_lshlrev_b32 v46, 16, v249
    v_and_b32 v47, s61, v249
    v_lshlrev_b32 v48, 16, v250
    v_and_b32 v49, s61, v250
    v_lshlrev_b32 v50, 16, v251
    v_and_b32 v51, s61, v251
    v_lshlrev_b32 v52, 16, v252
    v_and_b32 v53, s61, v252
    v_lshlrev_b32 v54, 16, v253
    v_and_b32 v55, s61, v253
    v_lshlrev_b32 v56, 16, v254
    v_and_b32 v57, s61, v254
    v_lshlrev_b32 v58, 16, v255
    v_and_b32 v59, s61, v255
    v_pk_add_f32 v[16:17], v[16:17], v[40:41]
    v_pk_add_f32 v[18:19], v[18:19], v[42:43]
    v_pk_add_f32 v[20:21], v[20:21], v[44:45]
    v_pk_add_f32 v[22:23], v[22:23], v[46:47]
    v_pk_add_f32 v[24:25], v[24:25], v[48:49]
    v_pk_add_f32 v[26:27], v[26:27], v[50:51]
    v_pk_add_f32 v[28:29], v[28:29], v[52:53]
    v_pk_add_f32 v[30:31], v[30:31], v[54:55]
    v_pk_add_f32 v[32:33], v[32:33], v[56:57]
    v_pk_add_f32 v[34:35], v[34:35], v[58:59]
    v_cvt_pk_bf16_f32 v246, v16, v17
    v_cvt_pk_bf16_f32 v247, v18, v19
    v_cvt_pk_bf16_f32 v248, v20, v21
    v_cvt_pk_bf16_f32 v249, v22, v23
    v_cvt_pk_bf16_f32 v250, v24, v25
    v_cvt_pk_bf16_f32 v251, v26, v27
    v_cvt_pk_bf16_f32 v252, v28, v29
    v_cvt_pk_bf16_f32 v253, v30, v31
    v_cvt_pk_bf16_f32 v254, v32, v33
    v_cvt_pk_bf16_f32 v255, v34, v35
    s_mov_b32 s61, 0xffff0000
    v_lshlrev_b32 v16, 16, v246
    v_and_b32 v17, s61, v246
    v_lshlrev_b32 v18, 16, v247
    v_and_b32 v19, s61, v247
    v_lshlrev_b32 v20, 16, v248
    v_and_b32 v21, s61, v248
    v_lshlrev_b32 v22, 16, v249
    v_and_b32 v23, s61, v249
    v_lshlrev_b32 v24, 16, v250
    v_and_b32 v25, s61, v250
    v_lshlrev_b32 v26, 16, v251
    v_and_b32 v27, s61, v251
    v_lshlrev_b32 v28, 16, v252
    v_and_b32 v29, s61, v252
    v_lshlrev_b32 v30, 16, v253
    v_and_b32 v31, s61, v253
    v_lshlrev_b32 v32, 16, v254
    v_and_b32 v33, s61, v254
    v_lshlrev_b32 v34, 16, v255
    v_and_b32 v35, s61, v255
    v_add_f32 v40, v16, v17
    v_mul_f32 v41, v16, v16
    v_fmac_f32 v41, v17, v17
    v_add_f32 v40, v40, v18
    v_fmac_f32 v41, v18, v18
    v_add_f32 v40, v40, v19
    v_fmac_f32 v41, v19, v19
    v_add_f32 v40, v40, v20
    v_fmac_f32 v41, v20, v20
    v_add_f32 v40, v40, v21
    v_fmac_f32 v41, v21, v21
    v_add_f32 v40, v40, v22
    v_fmac_f32 v41, v22, v22
    v_add_f32 v40, v40, v23
    v_fmac_f32 v41, v23, v23
    v_add_f32 v40, v40, v24
    v_fmac_f32 v41, v24, v24
    v_add_f32 v40, v40, v25
    v_fmac_f32 v41, v25, v25
    v_add_f32 v40, v40, v26
    v_fmac_f32 v41, v26, v26
    v_add_f32 v40, v40, v27
    v_fmac_f32 v41, v27, v27
    v_add_f32 v40, v40, v28
    v_fmac_f32 v41, v28, v28
    v_add_f32 v40, v40, v29
    v_fmac_f32 v41, v29, v29
    v_add_f32 v40, v40, v30
    v_fmac_f32 v41, v30, v30
    v_add_f32 v40, v40, v31
    v_fmac_f32 v41, v31, v31
    v_add_f32 v40, v40, v32
    v_fmac_f32 v41, v32, v32
    v_add_f32 v40, v40, v33
    v_fmac_f32 v41, v33, v33
    v_add_f32 v40, v40, v34
    v_fmac_f32 v41, v34, v34
    v_add_f32 v40, v40, v35
    v_fmac_f32 v41, v35, v35
    v_mov_b32 v42, v40
    s_nop 1
    v_permlane16_swap_b32 v40, v42
    v_add_f32 v40, v40, v42
    v_mov_b32 v42, v40
    s_nop 1
    v_permlane32_swap_b32 v40, v42
    v_add_f32 v40, v40, v42
    v_mov_b32 v42, v41
    s_nop 1
    v_permlane16_swap_b32 v41, v42
    v_add_f32 v41, v41, v42
    v_mov_b32 v42, v41
    s_nop 1
    v_permlane32_swap_b32 v41, v42
    v_add_f32 v41, v41, v42
    s_lshl_b32 s62, s56, 2
    s_add_u32 s62, s62, s52
    s_lshl_b32 s62, s62, 10
    v_and_b32 v43, 15, v0
    v_lshlrev_b32 v43, 6, v43
    v_add_u32 v43, s62, v43
    s_mul_i32 s63, s53, 131072
    s_add_u32 s63, s63, 327680
    s_lshl_b32 s61, s57, 3
    s_add_u32 s62, s61, s63
    s_mov_b64 exec, 0xffff
    buffer_store_dwordx2 v[40:41], v43, s[40:43], s62 offen sc1
    s_mov_b64 exec, -1
    v_and_b32 v44, 48, v0
    v_add_u32 v44, v43, v44
    s_mov_b32 s67, s63
    s_mul_i32 s64, s52, 40960
    s_add_u32 s64, s64, 28672
    v_and_b32 v2, 15, v0
    v_mul_u32_u24 v45, 160, v2
    v_lshrrev_b32 v3, 4, v0
    v_lshl_add_u32 v45, v3, 3, v45
    v_add_u32 v45, s64, v45
    v_lshrrev_b32 v4, 5, v0
    v_bfe_u32 v5, v0, 2, 2
    v_lshl_add_u32 v5, v4, 3, v5
    v_mul_u32_u24 v46, 160, v5
    v_and_b32 v5, 16, v0
    v_lshl_add_u32 v46, v5, 1, v46
    v_and_b32 v5, 3, v0
    v_lshl_add_u32 v46, v5, 3, v46
    v_add_u32 v46, s64, v46
    s_mul_i32 s65, s53, 2621440
    s_add_u32 s65, s65, 18874368
    s_lshl_b32 s66, s56, 2
    s_add_u32 s66, s66, s52
    s_lshl_b32 s66, s66, 10
    s_add_u32 s65, s65, s66
    s_mul_i32 s66, s57, 5
    v_bfe_u32 v5, v0, 4, 1
    v_add_u32 v5, s66, v5
    v_lshlrev_b32 v6, 9, v4
    v_lshl_add_u32 v6, v2, 4, v6
    v_add_u32 v7, 0, v5
    v_lshrrev_b32 v8, 1, v7
    v_lshlrev_b32 v8, 17, v8
    v_and_b32 v7, 1, v7
    v_lshl_add_u32 v8, v7, 8, v8
    v_add_u32 v47, v8, v6
    v_add_u32 v7, 2, v5
    v_lshrrev_b32 v8, 1, v7
    v_lshlrev_b32 v8, 17, v8
    v_and_b32 v7, 1, v7
    v_lshl_add_u32 v8, v7, 8, v8
    v_add_u32 v48, v8, v6
    v_add_u32 v7, 4, v5
    v_lshrrev_b32 v8, 1, v7
    v_lshlrev_b32 v8, 17, v8
    v_and_b32 v7, 1, v7
    v_lshl_add_u32 v8, v7, 8, v8
    v_add_u32 v49, v8, v6
    s_mov_b32 s82, 4194304
SPOLL_19:
    buffer_load_dwordx4 v[52:55], v44, s[40:43], s67 offen sc1
    s_sub_u32 s82, s82, 1
    s_cbranch_scc1 L_exit
    s_waitcnt vmcnt(0)
    v_max_u32 v56, v52, v53
    v_max3_u32 v56, v56, v54, v55
    v_cmp_eq_u32 vcc, -1, v56
    s_cbranch_vccnz SPOLL_19
    v_add_f32 v52, v52, v54
    v_add_f32 v53, v53, v55
    v_mov_b32 v54, v52
    s_nop 1
    v_permlane16_swap_b32 v52, v54
    v_add_f32 v52, v52, v54
    v_mov_b32 v54, v52
    s_nop 1
    v_permlane32_swap_b32 v52, v54
    v_add_f32 v52, v52, v54
    v_mov_b32 v54, v53
    s_nop 1
    v_permlane16_swap_b32 v53, v54
    v_add_f32 v53, v53, v54
    v_mov_b32 v54, v53
    s_nop 1
    v_permlane32_swap_b32 v53, v54
    v_add_f32 v53, v53, v54
    s_mov_b32 s61, 0x3acccccd
    s_mov_b32 s62, 0x3727c5ac
    v_mul_f32 v52, s61, v52
    v_mul_f32 v53, s61, v53
    v_fma_f32 v53, -v52, v52, v53
    v_max_f32 v53, 0, v53
    v_add_f32 v54, s62, v53
    v_rsq_f32 v54, v54
    s_nop 0
    v_mul_f32 v53, v53, v54
    v_fma_f32 v53, v53, v54, s62
    v_rsq_f32 v53, v53
    s_nop 0
    v_mul_f32 v54, v54, v53
    v_mul_f32 v56, -v52, v54
    v_pk_fma_f32 v[16:17], v[16:17], v[54:55], v[56:57] op_sel_hi:[1,0,0]
    v_pk_fma_f32 v[18:19], v[18:19], v[54:55], v[56:57] op_sel_hi:[1,0,0]
    v_pk_fma_f32 v[20:21], v[20:21], v[54:55], v[56:57] op_sel_hi:[1,0,0]
    v_pk_fma_f32 v[22:23], v[22:23], v[54:55], v[56:57] op_sel_hi:[1,0,0]
    v_pk_fma_f32 v[24:25], v[24:25], v[54:55], v[56:57] op_sel_hi:[1,0,0]
    v_pk_fma_f32 v[26:27], v[26:27], v[54:55], v[56:57] op_sel_hi:[1,0,0]
    v_pk_fma_f32 v[28:29], v[28:29], v[54:55], v[56:57] op_sel_hi:[1,0,0]
    v_pk_fma_f32 v[30:31], v[30:31], v[54:55], v[56:57] op_sel_hi:[1,0,0]
    v_pk_fma_f32 v[32:33], v[32:33], v[54:55], v[56:57] op_sel_hi:[1,0,0]
    v_pk_fma_f32 v[34:35], v[34:35], v[54:55], v[56:57] op_sel_hi:[1,0,0]
    v_cvt_pk_bf16_f32 v60, v16, v17
    v_cvt_pk_bf16_f32 v61, v18, v19
    v_cvt_pk_bf16_f32 v62, v20, v21
    v_cvt_pk_bf16_f32 v63, v22, v23
    v_cvt_pk_bf16_f32 v64, v24, v25
    v_cvt_pk_bf16_f32 v65, v26, v27
    v_cvt_pk_bf16_f32 v66, v28, v29
    v_cvt_pk_bf16_f32 v67, v30, v31
    v_cvt_pk_bf16_f32 v68, v32, v33
    v_cvt_pk_bf16_f32 v69, v34, v35
    ds_write_b64 v45, v[60:61] offset:0
    ds_write_b64 v45, v[62:63] offset:32
    ds_write_b64 v45, v[64:65] offset:64
    ds_write_b64 v45, v[66:67] offset:96
    ds_write_b64 v45, v[68:69] offset:128
    s_waitcnt lgkmcnt(0)
    ds_read_b64_tr_b16 v[72:73], v46 offset:0
    ds_read_b64_tr_b16 v[74:75], v46 offset:640
    ds_read_b64_tr_b16 v[76:77], v46 offset:64
    ds_read_b64_tr_b16 v[78:79], v46 offset:704
    ds_read_b64_tr_b16 v[80:81], v46 offset:128
    ds_read_b64_tr_b16 v[82:83], v46 offset:768
    s_mov_b32 s70, 0xffff
    s_mov_b32 s71, 0xffff
    s_waitcnt lgkmcnt(0)
    buffer_store_dwordx4 v[72:75], v47, s[40:43], s65 offen sc1
    buffer_store_dwordx4 v[76:79], v48, s[40:43], s65 offen sc1
    s_mov_b64 exec, s[70:71]
    buffer_store_dwordx4 v[80:83], v49, s[40:43], s65 offen sc1
    s_mov_b64 exec, -1
    s_lshl_b32 s61, s56, 2
    s_add_u32 s61, s61, s52
    s_lshl_b32 s61, s61, 5
    v_and_b32 v8, 15, v0
    v_lshlrev_b32 v8, 1, v8
    buffer_load_ushort v229, v8, s[28:31], s61 offen
    s_mul_i32 s63, s58, 205
    s_lshr_b32 s63, s63, 8
    s_mul_i32 s64, s58, 64
    s_add_u32 s64, s64, 63
    s_mul_i32 s64, s64, 820
    s_lshr_b32 s64, s64, 16
    s_sub_u32 s64, s64, s63
    s_lshl_b32 s64, s64, 7
    v_lshrrev_b32 v4, 5, v0
    v_mul_u32_u24 v4, s64, v4
    v_and_b32 v240, 31, v0
    v_lshlrev_b32 v240, 2, v240
    v_add_u32 v240, v4, v240
    s_lshl_b32 s69, s53, 16
    s_add_u32 s69, s69, 36651008
    s_lshl_b32 s68, s63, 7
    s_add_u32 s69, s69, s68
    s_lshl_b32 s68, s100, 10
    s_add_u32 s69, s69, s68
    s_lshl_b32 s101, s53, 16
    s_add_u32 s101, s101, 36651008
    s_lshl_b32 s68, s57, 7
    s_add_u32 s101, s101, s68
    s_lshl_b32 s68, s56, 2
    s_add_u32 s101, s101, s68
    v_lshlrev_b32 v1, 10, v0
    s_waitcnt vmcnt(1)
    s_barrier
    s_cmp_lg_u32 s52, 0
    s_cbranch_scc1 W0_20
    s_mov_b64 exec, 255
    buffer_atomic_swap v243, v1, s[40:43], s101 offen sc1
    s_mov_b64 exec, -1
W0_20:
    s_mul_i32 s61, s52, 1572864
    s_lshl_b32 s62, s56, 7
    s_add_u32 s61, s61, s62
    s_mul_i32 s62, s52, 40960
    s_add_u32 m0, s62, 0
    s_add_u32 s63, s61, 0
    buffer_load_dwordx4 v228, s[20:23], s63 offen lds
    s_add_u32 m0, s62, 1024
    s_add_u32 s63, s61, 32768
    buffer_load_dwordx4 v228, s[20:23], s63 offen lds
    s_add_u32 m0, s62, 2048
    s_add_u32 s63, s61, 65536
    buffer_load_dwordx4 v228, s[20:23], s63 offen lds
    s_add_u32 m0, s62, 3072
    s_add_u32 s63, s61, 98304
    buffer_load_dwordx4 v228, s[20:23], s63 offen lds
    s_add_u32 m0, s62, 4096
    s_add_u32 s63, s61, 131072
    buffer_load_dwordx4 v228, s[20:23], s63 offen lds
    s_add_u32 m0, s62, 5120
    s_add_u32 s63, s61, 163840
    buffer_load_dwordx4 v228, s[20:23], s63 offen lds
    s_add_u32 m0, s62, 6144
    s_add_u32 s63, s61, 196608
    buffer_load_dwordx4 v228, s[20:23], s63 offen lds
    s_add_u32 m0, s62, 7168
    s_add_u32 s63, s61, 229376
    buffer_load_dwordx4 v228, s[20:23], s63 offen lds
    s_add_u32 m0, s62, 8192
    s_add_u32 s63, s61, 262144
    buffer_load_dwordx4 v228, s[20:23], s63 offen lds
    s_add_u32 m0, s62, 9216
    s_add_u32 s63, s61, 294912
    buffer_load_dwordx4 v228, s[20:23], s63 offen lds
    s_add_u32 m0, s62, 10240
    s_add_u32 s63, s61, 327680
    buffer_load_dwordx4 v228, s[20:23], s63 offen lds
    s_add_u32 m0, s62, 11264
    s_add_u32 s63, s61, 360448
    buffer_load_dwordx4 v228, s[20:23], s63 offen lds
    s_add_u32 m0, s62, 12288
    s_add_u32 s63, s61, 393216
    buffer_load_dwordx4 v228, s[20:23], s63 offen lds
    s_add_u32 m0, s62, 13312
    s_add_u32 s63, s61, 425984
    buffer_load_dwordx4 v228, s[20:23], s63 offen lds
    s_add_u32 m0, s62, 14336
    s_add_u32 s63, s61, 458752
    buffer_load_dwordx4 v228, s[20:23], s63 offen lds
    s_add_u32 m0, s62, 15360
    s_add_u32 s63, s61, 491520
    buffer_load_dwordx4 v228, s[20:23], s63 offen lds
    s_add_u32 m0, s62, 16384
    s_add_u32 s63, s61, 524288
    buffer_load_dwordx4 v228, s[20:23], s63 offen lds
    s_add_u32 m0, s62, 17408
    s_add_u32 s63, s61, 557056
    buffer_load_dwordx4 v228, s[20:23], s63 offen lds
    s_add_u32 m0, s62, 18432
    s_add_u32 s63, s61, 589824
    buffer_load_dwordx4 v228, s[20:23], s63 offen lds
    s_add_u32 m0, s62, 19456
    s_add_u32 s63, s61, 622592
    buffer_load_dwordx4 v228, s[20:23], s63 offen lds
    s_add_u32 m0, s62, 20480
    s_add_u32 s63, s61, 655360
    buffer_load_dwordx4 v228, s[20:23], s63 offen lds
    s_add_u32 m0, s62, 21504
    s_add_u32 s63, s61, 688128
    buffer_load_dwordx4 v228, s[20:23], s63 offen lds
    s_add_u32 m0, s62, 22528
    s_add_u32 s63, s61, 720896
    buffer_load_dwordx4 v228, s[20:23], s63 offen lds
    s_add_u32 m0, s62, 23552
    s_add_u32 s63, s61, 753664
    buffer_load_dwordx4 v228, s[20:23], s63 offen lds
    s_add_u32 m0, s62, 24576
    s_add_u32 s63, s61, 786432
    buffer_load_dwordx4 v228, s[20:23], s63 offen lds
    s_add_u32 m0, s62, 25600
    s_add_u32 s63, s61, 819200
    buffer_load_dwordx4 v228, s[20:23], s63 offen lds
    s_add_u32 m0, s62, 26624
    s_add_u32 s63, s61, 851968
    buffer_load_dwordx4 v228, s[20:23], s63 offen lds
    s_add_u32 m0, s62, 27648
    s_add_u32 s63, s61, 884736
    buffer_load_dwordx4 v228, s[20:23], s63 offen lds
    s_cmp_eq_u32 s60, 0
    s_cbranch_scc1 NOG1_21
    s_lshl_b32 s61, s59, 7
    s_lshr_b32 s62, s52, 1
    s_lshl_b32 s62, s62, 6
    s_add_u32 s61, s61, s62
    v_lshrrev_b32 v2, 5, v0
    v_lshlrev_b32 v2, 3, v2
    buffer_load_dwordx2 v[208:209], v2, s[24:27], s61 offen offset:0
    buffer_load_dwordx2 v[210:211], v2, s[24:27], s61 offen offset:16
    buffer_load_dwordx2 v[212:213], v2, s[24:27], s61 offen offset:32
    buffer_load_dwordx2 v[214:215], v2, s[24:27], s61 offen offset:48
    s_mul_i32 s61, s53, 2621440
    s_add_u32 s61, s61, 18874368
    s_lshl_b32 s62, s58, 18
    s_add_u32 s61, s61, s62
    s_lshl_b32 s62, s52, 15
    s_add_u32 s61, s61, s62
    s_and_b32 s62, s52, 1
    s_lshl_b32 s62, s62, 17
    v_lshlrev_b32 v2, 4, v0
    v_add_u32 v2, s62, v2
    v_xor_b32 v3, 0x20000, v2
    s_cmp_lg_u32 s52, 0
    s_cbranch_scc1 W0_22
    s_mov_b32 s82, 4194304
FW_23:
    buffer_load_dword v1, v240, s[40:43], s69 offen sc1
    s_sub_u32 s82, s82, 1
    s_cbranch_scc1 L_exit
    s_waitcnt vmcnt(0)
    v_cmp_ne_u32 vcc, s99, v1
    s_cbranch_vccnz FW_23
W0_22:
    s_barrier
    buffer_load_dwordx4 v[80:83], v2, s[40:43], s61 offen offset:0
    buffer_load_dwordx4 v[84:87], v3, s[40:43], s61 offen offset:0
    buffer_load_dwordx4 v[88:91], v2, s[40:43], s61 offen offset:1024
    buffer_load_dwordx4 v[92:95], v3, s[40:43], s61 offen offset:1024
    buffer_load_dwordx4 v[96:99], v2, s[40:43], s61 offen offset:2048
    buffer_load_dwordx4 v[100:103], v3, s[40:43], s61 offen offset:2048
    buffer_load_dwordx4 v[104:107], v2, s[40:43], s61 offen offset:3072
    buffer_load_dwordx4 v[108:111], v3, s[40:43], s61 offen offset:3072
    s_add_u32 s61, s61, 4096
    buffer_load_dwordx4 v[112:115], v2, s[40:43], s61 offen offset:0
    buffer_load_dwordx4 v[116:119], v3, s[40:43], s61 offen offset:0
    buffer_load_dwordx4 v[120:123], v2, s[40:43], s61 offen offset:1024
    buffer_load_dwordx4 v[124:127], v3, s[40:43], s61 offen offset:1024
    buffer_load_dwordx4 v[128:131], v2, s[40:43], s61 offen offset:2048
    buffer_load_dwordx4 v[132:135], v3, s[40:43], s61 offen offset:2048
    buffer_load_dwordx4 v[136:139], v2, s[40:43], s61 offen offset:3072
    buffer_load_dwordx4 v[140:143], v3, s[40:43], s61 offen offset:3072
    s_add_u32 s61, s61, 4096
    buffer_load_dwordx4 v[144:147], v2, s[40:43], s61 offen offset:0
    buffer_load_dwordx4 v[148:151], v3, s[40:43], s61 offen offset:0
    buffer_load_dwordx4 v[152:155], v2, s[40:43], s61 offen offset:1024
    buffer_load_dwordx4 v[156:159], v3, s[40:43], s61 offen offset:1024
    buffer_load_dwordx4 v[160:163], v2, s[40:43], s61 offen offset:2048
    buffer_load_dwordx4 v[164:167], v3, s[40:43], s61 offen offset:2048
    buffer_load_dwordx4 v[168:171], v2, s[40:43], s61 offen offset:3072
    buffer_load_dwordx4 v[172:175], v3, s[40:43], s61 offen offset:3072
    s_add_u32 s61, s61, 4096
    buffer_load_dwordx4 v[176:179], v2, s[40:43], s61 offen offset:0
    buffer_load_dwordx4 v[180:183], v3, s[40:43], s61 offen offset:0
    buffer_load_dwordx4 v[184:187], v2, s[40:43], s61 offen offset:1024
    buffer_load_dwordx4 v[188:191], v3, s[40:43], s61 offen offset:1024
    buffer_load_dwordx4 v[192:195], v2, s[40:43], s61 offen offset:2048
    buffer_load_dwordx4 v[196:199], v3, s[40:43], s61 offen offset:2048
    buffer_load_dwordx4 v[200:203], v2, s[40:43], s61 offen offset:3072
    buffer_load_dwordx4 v[204:207], v3, s[40:43], s61 offen offset:3072
    s_add_u32 s61, s61, 4096
    s_waitcnt vmcnt(30)
    v_mfma_f32_32x32x16_bf16 v[16:31], a[0:3], v[80:83], 0
    v_mfma_f32_32x32x16_bf16 v[32:47], a[0:3], v[84:87], 0
    v_mfma_f32_32x32x16_bf16 v[48:63], a[4:7], v[80:83], 0
    v_mfma_f32_32x32x16_bf16 v[64:79], a[4:7], v[84:87], 0
    buffer_load_dwordx4 v[80:83], v2, s[40:43], s61 offen offset:0
    buffer_load_dwordx4 v[84:87], v3, s[40:43], s61 offen offset:0
    s_waitcnt vmcnt(30)
    v_mfma_f32_32x32x16_bf16 v[16:31], a[8:11], v[88:91], v[16:31]
    v_mfma_f32_32x32x16_bf16 v[32:47], a[8:11], v[92:95], v[32:47]
    v_mfma_f32_32x32x16_bf16 v[48:63], a[12:15], v[88:91], v[48:63]
    v_mfma_f32_32x32x16_bf16 v[64:79], a[12:15], v[92:95], v[64:79]
    buffer_load_dwordx4 v[88:91], v2, s[40:43], s61 offen offset:1024
    buffer_load_dwordx4 v[92:95], v3, s[40:43], s61 offen offset:1024
    s_waitcnt vmcnt(30)
    v_mfma_f32_32x32x16_bf16 v[16:31], a[16:19], v[96:99], v[16:31]
    v_mfma_f32_32x32x16_bf16 v[32:47], a[16:19], v[100:103], v[32:47]
    v_mfma_f32_32x32x16_bf16 v[48:63], a[20:23], v[96:99], v[48:63]
    v_mfma_f32_32x32x16_bf16 v[64:79], a[20:23], v[100:103], v[64:79]
    buffer_load_dwordx4 v[96:99], v2, s[40:43], s61 offen offset:2048
    buffer_load_dwordx4 v[100:103], v3, s[40:43], s61 offen offset:2048
    s_waitcnt vmcnt(30)
    v_mfma_f32_32x32x16_bf16 v[16:31], a[24:27], v[104:107], v[16:31]
    v_mfma_f32_32x32x16_bf16 v[32:47], a[24:27], v[108:111], v[32:47]
    v_mfma_f32_32x32x16_bf16 v[48:63], a[28:31], v[104:107], v[48:63]
    v_mfma_f32_32x32x16_bf16 v[64:79], a[28:31], v[108:111], v[64:79]
    buffer_load_dwordx4 v[104:107], v2, s[40:43], s61 offen offset:3072
    buffer_load_dwordx4 v[108:111], v3, s[40:43], s61 offen offset:3072
    s_add_u32 s61, s61, 4096
    s_waitcnt vmcnt(30)
    v_mfma_f32_32x32x16_bf16 v[16:31], a[32:35], v[112:115], v[16:31]
    v_mfma_f32_32x32x16_bf16 v[32:47], a[32:35], v[116:119], v[32:47]
    v_mfma_f32_32x32x16_bf16 v[48:63], a[36:39], v[112:115], v[48:63]
    v_mfma_f32_32x32x16_bf16 v[64:79], a[36:39], v[116:119], v[64:79]
    buffer_load_dwordx4 v[112:115], v2, s[40:43], s61 offen offset:0
    buffer_load_dwordx4 v[116:119], v3, s[40:43], s61 offen offset:0
    s_waitcnt vmcnt(30)
    v_mfma_f32_32x32x16_bf16 v[16:31], a[40:43], v[120:123], v[16:31]
    v_mfma_f32_32x32x16_bf16 v[32:47], a[40:43], v[124:127], v[32:47]
    v_mfma_f32_32x32x16_bf16 v[48:63], a[44:47], v[120:123], v[48:63]
    v_mfma_f32_32x32x16_bf16 v[64:79], a[44:47], v[124:127], v[64:79]
    buffer_load_dwordx4 v[120:123], v2, s[40:43], s61 offen offset:1024
    buffer_load_dwordx4 v[124:127], v3, s[40:43], s61 offen offset:1024
    s_waitcnt vmcnt(30)
    v_mfma_f32_32x32x16_bf16 v[16:31], a[48:51], v[128:131], v[16:31]
    v_mfma_f32_32x32x16_bf16 v[32:47], a[48:51], v[132:135], v[32:47]
    v_mfma_f32_32x32x16_bf16 v[48:63], a[52:55], v[128:131], v[48:63]
    v_mfma_f32_32x32x16_bf16 v[64:79], a[52:55], v[132:135], v[64:79]
    buffer_load_dwordx4 v[128:131], v2, s[40:43], s61 offen offset:2048
    buffer_load_dwordx4 v[132:135], v3, s[40:43], s61 offen offset:2048
    s_waitcnt vmcnt(30)
    v_mfma_f32_32x32x16_bf16 v[16:31], a[56:59], v[136:139], v[16:31]
    v_mfma_f32_32x32x16_bf16 v[32:47], a[56:59], v[140:143], v[32:47]
    v_mfma_f32_32x32x16_bf16 v[48:63], a[60:63], v[136:139], v[48:63]
    v_mfma_f32_32x32x16_bf16 v[64:79], a[60:63], v[140:143], v[64:79]
    buffer_load_dwordx4 v[136:139], v2, s[40:43], s61 offen offset:3072
    buffer_load_dwordx4 v[140:143], v3, s[40:43], s61 offen offset:3072
    s_add_u32 s61, s61, 4096
    s_waitcnt vmcnt(30)
    v_mfma_f32_32x32x16_bf16 v[16:31], a[64:67], v[144:147], v[16:31]
    v_mfma_f32_32x32x16_bf16 v[32:47], a[64:67], v[148:151], v[32:47]
    v_mfma_f32_32x32x16_bf16 v[48:63], a[68:71], v[144:147], v[48:63]
    v_mfma_f32_32x32x16_bf16 v[64:79], a[68:71], v[148:151], v[64:79]
    buffer_load_dwordx4 v[144:147], v2, s[40:43], s61 offen offset:0
    buffer_load_dwordx4 v[148:151], v3, s[40:43], s61 offen offset:0
    s_waitcnt vmcnt(30)
    v_mfma_f32_32x32x16_bf16 v[16:31], a[72:75], v[152:155], v[16:31]
    v_mfma_f32_32x32x16_bf16 v[32:47], a[72:75], v[156:159], v[32:47]
    v_mfma_f32_32x32x16_bf16 v[48:63], a[76:79], v[152:155], v[48:63]
    v_mfma_f32_32x32x16_bf16 v[64:79], a[76:79], v[156:159], v[64:79]
    buffer_load_dwordx4 v[152:155], v2, s[40:43], s61 offen offset:1024
    buffer_load_dwordx4 v[156:159], v3, s[40:43], s61 offen offset:1024
    s_waitcnt vmcnt(30)
    v_mfma_f32_32x32x16_bf16 v[16:31], a[80:83], v[160:163], v[16:31]
    v_mfma_f32_32x32x16_bf16 v[32:47], a[80:83], v[164:167], v[32:47]
    v_mfma_f32_32x32x16_bf16 v[48:63], a[84:87], v[160:163], v[48:63]
    v_mfma_f32_32x32x16_bf16 v[64:79], a[84:87], v[164:167], v[64:79]
    buffer_load_dwordx4 v[160:163], v2, s[40:43], s61 offen offset:2048
    buffer_load_dwordx4 v[164:167], v3, s[40:43], s61 offen offset:2048
    s_waitcnt vmcnt(30)
    v_mfma_f32_32x32x16_bf16 v[16:31], a[88:91], v[168:171], v[16:31]
    v_mfma_f32_32x32x16_bf16 v[32:47], a[88:91], v[172:175], v[32:47]
    v_mfma_f32_32x32x16_bf16 v[48:63], a[92:95], v[168:171], v[48:63]
    v_mfma_f32_32x32x16_bf16 v[64:79], a[92:95], v[172:175], v[64:79]
    buffer_load_dwordx4 v[168:171], v2, s[40:43], s61 offen offset:3072
    buffer_load_dwordx4 v[172:175], v3, s[40:43], s61 offen offset:3072
    s_add_u32 s61, s61, 4096
    s_waitcnt vmcnt(30)
    v_mfma_f32_32x32x16_bf16 v[16:31], a[96:99], v[176:179], v[16:31]
    v_mfma_f32_32x32x16_bf16 v[32:47], a[96:99], v[180:183], v[32:47]
    v_mfma_f32_32x32x16_bf16 v[48:63], a[100:103], v[176:179], v[48:63]
    v_mfma_f32_32x32x16_bf16 v[64:79], a[100:103], v[180:183], v[64:79]
    buffer_load_dwordx4 v[176:179], v2, s[40:43], s61 offen offset:0
    buffer_load_dwordx4 v[180:183], v3, s[40:43], s61 offen offset:0
    s_waitcnt vmcnt(30)
    v_mfma_f32_32x32x16_bf16 v[16:31], a[104:107], v[184:187], v[16:31]
    v_mfma_f32_32x32x16_bf16 v[32:47], a[104:107], v[188:191], v[32:47]
    v_mfma_f32_32x32x16_bf16 v[48:63], a[108:111], v[184:187], v[48:63]
    v_mfma_f32_32x32x16_bf16 v[64:79], a[108:111], v[188:191], v[64:79]
    buffer_load_dwordx4 v[184:187], v2, s[40:43], s61 offen offset:1024
    buffer_load_dwordx4 v[188:191], v3, s[40:43], s61 offen offset:1024
    s_waitcnt vmcnt(30)
    v_mfma_f32_32x32x16_bf16 v[16:31], a[112:115], v[192:195], v[16:31]
    v_mfma_f32_32x32x16_bf16 v[32:47], a[112:115], v[196:199], v[32:47]
    v_mfma_f32_32x32x16_bf16 v[48:63], a[116:119], v[192:195], v[48:63]
    v_mfma_f32_32x32x16_bf16 v[64:79], a[116:119], v[196:199], v[64:79]
    buffer_load_dwordx4 v[192:195], v2, s[40:43], s61 offen offset:2048
    buffer_load_dwordx4 v[196:199], v3, s[40:43], s61 offen offset:2048
    s_waitcnt vmcnt(30)
    v_mfma_f32_32x32x16_bf16 v[16:31], a[120:123], v[200:203], v[16:31]
    v_mfma_f32_32x32x16_bf16 v[32:47], a[120:123], v[204:207], v[32:47]
    v_mfma_f32_32x32x16_bf16 v[48:63], a[124:127], v[200:203], v[48:63]
    v_mfma_f32_32x32x16_bf16 v[64:79], a[124:127], v[204:207], v[64:79]
    buffer_load_dwordx4 v[200:203], v2, s[40:43], s61 offen offset:3072
    buffer_load_dwordx4 v[204:207], v3, s[40:43], s61 offen offset:3072
    s_add_u32 s61, s61, 4096
    s_waitcnt vmcnt(30)
    v_mfma_f32_32x32x16_bf16 v[16:31], a[128:131], v[80:83], v[16:31]
    v_mfma_f32_32x32x16_bf16 v[32:47], a[128:131], v[84:87], v[32:47]
    v_mfma_f32_32x32x16_bf16 v[48:63], a[132:135], v[80:83], v[48:63]
    v_mfma_f32_32x32x16_bf16 v[64:79], a[132:135], v[84:87], v[64:79]
    s_waitcnt vmcnt(28)
    v_mfma_f32_32x32x16_bf16 v[16:31], a[136:139], v[88:91], v[16:31]
    v_mfma_f32_32x32x16_bf16 v[32:47], a[136:139], v[92:95], v[32:47]
    v_mfma_f32_32x32x16_bf16 v[48:63], a[140:143], v[88:91], v[48:63]
    v_mfma_f32_32x32x16_bf16 v[64:79], a[140:143], v[92:95], v[64:79]
    s_waitcnt vmcnt(26)
    v_mfma_f32_32x32x16_bf16 v[16:31], a[144:147], v[96:99], v[16:31]
    v_mfma_f32_32x32x16_bf16 v[32:47], a[144:147], v[100:103], v[32:47]
    v_mfma_f32_32x32x16_bf16 v[48:63], a[148:151], v[96:99], v[48:63]
    v_mfma_f32_32x32x16_bf16 v[64:79], a[148:151], v[100:103], v[64:79]
    s_waitcnt vmcnt(24)
    v_mfma_f32_32x32x16_bf16 v[16:31], a[152:155], v[104:107], v[16:31]
    v_mfma_f32_32x32x16_bf16 v[32:47], a[152:155], v[108:111], v[32:47]
    v_mfma_f32_32x32x16_bf16 v[48:63], a[156:159], v[104:107], v[48:63]
    v_mfma_f32_32x32x16_bf16 v[64:79], a[156:159], v[108:111], v[64:79]
    s_waitcnt vmcnt(22)
    v_mfma_f32_32x32x16_bf16 v[16:31], a[160:163], v[112:115], v[16:31]
    v_mfma_f32_32x32x16_bf16 v[32:47], a[160:163], v[116:119], v[32:47]
    v_mfma_f32_32x32x16_bf16 v[48:63], a[164:167], v[112:115], v[48:63]
    v_mfma_f32_32x32x16_bf16 v[64:79], a[164:167], v[116:119], v[64:79]
    s_waitcnt vmcnt(20)
    v_mfma_f32_32x32x16_bf16 v[16:31], a[168:171], v[120:123], v[16:31]
    v_mfma_f32_32x32x16_bf16 v[32:47], a[168:171], v[124:127], v[32:47]
    v_mfma_f32_32x32x16_bf16 v[48:63], a[172:175], v[120:123], v[48:63]
    v_mfma_f32_32x32x16_bf16 v[64:79], a[172:175], v[124:127], v[64:79]
    s_waitcnt vmcnt(18)
    v_mfma_f32_32x32x16_bf16 v[16:31], a[176:179], v[128:131], v[16:31]
    v_mfma_f32_32x32x16_bf16 v[32:47], a[176:179], v[132:135], v[32:47]
    v_mfma_f32_32x32x16_bf16 v[48:63], a[180:183], v[128:131], v[48:63]
    v_mfma_f32_32x32x16_bf16 v[64:79], a[180:183], v[132:135], v[64:79]
    s_waitcnt vmcnt(16)
    v_mfma_f32_32x32x16_bf16 v[16:31], a[184:187], v[136:139], v[16:31]
    v_mfma_f32_32x32x16_bf16 v[32:47], a[184:187], v[140:143], v[32:47]
    v_mfma_f32_32x32x16_bf16 v[48:63], a[188:191], v[136:139], v[48:63]
    v_mfma_f32_32x32x16_bf16 v[64:79], a[188:191], v[140:143], v[64:79]
    s_waitcnt vmcnt(14)
    v_mfma_f32_32x32x16_bf16 v[16:31], a[192:195], v[144:147], v[16:31]
    v_mfma_f32_32x32x16_bf16 v[32:47], a[192:195], v[148:151], v[32:47]
    v_mfma_f32_32x32x16_bf16 v[48:63], a[196:199], v[144:147], v[48:63]
    v_mfma_f32_32x32x16_bf16 v[64:79], a[196:199], v[148:151], v[64:79]
    s_waitcnt vmcnt(12)
    v_mfma_f32_32x32x16_bf16 v[16:31], a[200:203], v[152:155], v[16:31]
    v_mfma_f32_32x32x16_bf16 v[32:47], a[200:203], v[156:159], v[32:47]
    v_mfma_f32_32x32x16_bf16 v[48:63], a[204:207], v[152:155], v[48:63]
    v_mfma_f32_32x32x16_bf16 v[64:79], a[204:207], v[156:159], v[64:79]
    s_waitcnt vmcnt(10)
    v_mfma_f32_32x32x16_bf16 v[16:31], a[208:211], v[160:163], v[16:31]
    v_mfma_f32_32x32x16_bf16 v[32:47], a[208:211], v[164:167], v[32:47]
    v_mfma_f32_32x32x16_bf16 v[48:63], a[212:215], v[160:163], v[48:63]
    v_mfma_f32_32x32x16_bf16 v[64:79], a[212:215], v[164:167], v[64:79]
    s_waitcnt vmcnt(8)
    v_mfma_f32_32x32x16_bf16 v[16:31], a[216:219], v[168:171], v[16:31]
    v_mfma_f32_32x32x16_bf16 v[32:47], a[216:219], v[172:175], v[32:47]
    v_mfma_f32_32x32x16_bf16 v[48:63], a[220:223], v[168:171], v[48:63]
    v_mfma_f32_32x32x16_bf16 v[64:79], a[220:223], v[172:175], v[64:79]
    s_waitcnt vmcnt(6)
    v_mfma_f32_32x32x16_bf16 v[16:31], a[224:227], v[176:179], v[16:31]
    v_mfma_f32_32x32x16_bf16 v[32:47], a[224:227], v[180:183], v[32:47]
    v_mfma_f32_32x32x16_bf16 v[48:63], a[228:231], v[176:179], v[48:63]
    v_mfma_f32_32x32x16_bf16 v[64:79], a[228:231], v[180:183], v[64:79]
    s_waitcnt vmcnt(4)
    v_mfma_f32_32x32x16_bf16 v[16:31], a[232:235], v[184:187], v[16:31]
    v_mfma_f32_32x32x16_bf16 v[32:47], a[232:235], v[188:191], v[32:47]
    v_mfma_f32_32x32x16_bf16 v[48:63], a[236:239], v[184:187], v[48:63]
    v_mfma_f32_32x32x16_bf16 v[64:79], a[236:239], v[188:191], v[64:79]
    s_waitcnt vmcnt(2)
    v_mfma_f32_32x32x16_bf16 v[16:31], a[240:243], v[192:195], v[16:31]
    v_mfma_f32_32x32x16_bf16 v[32:47], a[240:243], v[196:199], v[32:47]
    v_mfma_f32_32x32x16_bf16 v[48:63], a[244:247], v[192:195], v[48:63]
    v_mfma_f32_32x32x16_bf16 v[64:79], a[244:247], v[196:199], v[64:79]
    s_waitcnt vmcnt(0)
    v_mfma_f32_32x32x16_bf16 v[16:31], a[248:251], v[200:203], v[16:31]
    v_mfma_f32_32x32x16_bf16 v[32:47], a[248:251], v[204:207], v[32:47]
    v_mfma_f32_32x32x16_bf16 v[48:63], a[252:255], v[200:203], v[48:63]
    v_mfma_f32_32x32x16_bf16 v[64:79], a[252:255], v[204:207], v[64:79]
    v_lshlrev_b32 v4, 4, v0
    s_xor_b32 s61, s52, 1
    s_mul_i32 s61, s61, 40960
    s_add_u32 s61, s61, 28672
    v_add_u32 v5, s61, v4
    s_xor_b32 s61, s52, 2
    s_mul_i32 s61, s61, 40960
    s_add_u32 s61, s61, 32768
    v_add_u32 v6, s61, v4
    s_xor_b32 s61, s52, 3
    s_mul_i32 s61, s61, 40960
    s_add_u32 s61, s61, 36864
    v_add_u32 v7, s61, v4
    s_mul_i32 s61, s52, 40960
    s_add_u32 s61, s61, 28672
    v_add_u32 v4, s61, v4
    ds_write_b128 v5, v[32:35] offset:0
    ds_write_b128 v5, v[36:39] offset:1024
    ds_write_b128 v5, v[40:43] offset:2048
    ds_write_b128 v5, v[44:47] offset:3072
    ds_write_b128 v6, v[48:51] offset:0
    ds_write_b128 v6, v[52:55] offset:1024
    ds_write_b128 v6, v[56:59] offset:2048
    ds_write_b128 v6, v[60:63] offset:3072
    ds_write_b128 v7, v[64:67] offset:0
    ds_write_b128 v7, v[68:71] offset:1024
    ds_write_b128 v7, v[72:75] offset:2048
    ds_write_b128 v7, v[76:79] offset:3072
    s_waitcnt lgkmcnt(0)
    s_barrier
    ds_read_b128 v[80:83], v4 offset:0
    ds_read_b128 v[84:87], v4 offset:1024
    ds_read_b128 v[88:91], v4 offset:2048
    ds_read_b128 v[92:95], v4 offset:3072
    ds_read_b128 v[96:99], v4 offset:4096
    ds_read_b128 v[100:103], v4 offset:5120
    ds_read_b128 v[104:107], v4 offset:6144
    ds_read_b128 v[108:111], v4 offset:7168
    ds_read_b128 v[112:115], v4 offset:8192
    ds_read_b128 v[116:119], v4 offset:9216
    ds_read_b128 v[120:123], v4 offset:10240
    ds_read_b128 v[124:127], v4 offset:11264
    s_mov_b32 s61, 0xffff0000
    v_lshlrev_b32 v128, 16, v208
    v_and_b32 v129, s61, v208
    v_lshlrev_b32 v130, 16, v209
    v_and_b32 v131, s61, v209
    v_lshlrev_b32 v132, 16, v210
    v_and_b32 v133, s61, v210
    v_lshlrev_b32 v134, 16, v211
    v_and_b32 v135, s61, v211
    v_lshlrev_b32 v136, 16, v212
    v_and_b32 v137, s61, v212
    v_lshlrev_b32 v138, 16, v213
    v_and_b32 v139, s61, v213
    v_lshlrev_b32 v140, 16, v214
    v_and_b32 v141, s61, v214
    v_lshlrev_b32 v142, 16, v215
    v_and_b32 v143, s61, v215
    v_pk_add_f32 v[16:17], v[16:17], v[128:129]
    v_pk_add_f32 v[18:19], v[18:19], v[130:131]
    v_pk_add_f32 v[20:21], v[20:21], v[132:133]
    v_pk_add_f32 v[22:23], v[22:23], v[134:135]
    v_pk_add_f32 v[24:25], v[24:25], v[136:137]
    v_pk_add_f32 v[26:27], v[26:27], v[138:139]
    v_pk_add_f32 v[28:29], v[28:29], v[140:141]
    v_pk_add_f32 v[30:31], v[30:31], v[142:143]
    s_waitcnt lgkmcnt(8)
    v_pk_add_f32 v[16:17], v[16:17], v[80:81]
    v_pk_add_f32 v[18:19], v[18:19], v[82:83]
    v_pk_add_f32 v[20:21], v[20:21], v[84:85]
    v_pk_add_f32 v[22:23], v[22:23], v[86:87]
    v_pk_add_f32 v[24:25], v[24:25], v[88:89]
    v_pk_add_f32 v[26:27], v[26:27], v[90:91]
    v_pk_add_f32 v[28:29], v[28:29], v[92:93]
    v_pk_add_f32 v[30:31], v[30:31], v[94:95]
    s_waitcnt lgkmcnt(4)
    v_pk_add_f32 v[16:17], v[16:17], v[96:97]
    v_pk_add_f32 v[18:19], v[18:19], v[98:99]
    v_pk_add_f32 v[20:21], v[20:21], v[100:101]
    v_pk_add_f32 v[22:23], v[22:23], v[102:103]
    v_pk_add_f32 v[24:25], v[24:25], v[104:105]
    v_pk_add_f32 v[26:27], v[26:27], v[106:107]
    v_pk_add_f32 v[28:29], v[28:29], v[108:109]
    v_pk_add_f32 v[30:31], v[30:31], v[110:111]
    s_waitcnt lgkmcnt(0)
    v_pk_add_f32 v[16:17], v[16:17], v[112:113]
    v_pk_add_f32 v[18:19], v[18:19], v[114:115]
    v_pk_add_f32 v[20:21], v[20:21], v[116:117]
    v_pk_add_f32 v[22:23], v[22:23], v[118:119]
    v_pk_add_f32 v[24:25], v[24:25], v[120:121]
    v_pk_add_f32 v[26:27], v[26:27], v[122:123]
    v_pk_add_f32 v[28:29], v[28:29], v[124:125]
    v_pk_add_f32 v[30:31], v[30:31], v[126:127]
    v_mov_b32 v8, 0xc0135761
    v_mov_b32 v10, 0xbdd2d3e8
    v_pk_mul_f32 v[32:33], v[16:17], v[16:17]
    v_pk_mul_f32 v[34:35], v[18:19], v[18:19]
    v_pk_mul_f32 v[36:37], v[20:21], v[20:21]
    v_pk_mul_f32 v[38:39], v[22:23], v[22:23]
    v_pk_mul_f32 v[40:41], v[24:25], v[24:25]
    v_pk_mul_f32 v[42:43], v[26:27], v[26:27]
    v_pk_mul_f32 v[44:45], v[28:29], v[28:29]
    v_pk_mul_f32 v[46:47], v[30:31], v[30:31]
    v_pk_fma_f32 v[32:33], v[32:33], v[10:11], v[8:9] op_sel_hi:[1,0,0]
    v_pk_fma_f32 v[34:35], v[34:35], v[10:11], v[8:9] op_sel_hi:[1,0,0]
    v_pk_fma_f32 v[36:37], v[36:37], v[10:11], v[8:9] op_sel_hi:[1,0,0]
    v_pk_fma_f32 v[38:39], v[38:39], v[10:11], v[8:9] op_sel_hi:[1,0,0]
    v_pk_fma_f32 v[40:41], v[40:41], v[10:11], v[8:9] op_sel_hi:[1,0,0]
    v_pk_fma_f32 v[42:43], v[42:43], v[10:11], v[8:9] op_sel_hi:[1,0,0]
    v_pk_fma_f32 v[44:45], v[44:45], v[10:11], v[8:9] op_sel_hi:[1,0,0]
    v_pk_fma_f32 v[46:47], v[46:47], v[10:11], v[8:9] op_sel_hi:[1,0,0]
    v_pk_mul_f32 v[32:33], v[32:33], v[16:17]
    v_pk_mul_f32 v[34:35], v[34:35], v[18:19]
    v_pk_mul_f32 v[36:37], v[36:37], v[20:21]
    v_pk_mul_f32 v[38:39], v[38:39], v[22:23]
    v_pk_mul_f32 v[40:41], v[40:41], v[24:25]
    v_pk_mul_f32 v[42:43], v[42:43], v[26:27]
    v_pk_mul_f32 v[44:45], v[44:45], v[28:29]
    v_pk_mul_f32 v[46:47], v[46:47], v[30:31]
    v_exp_f32 v32, v32
    v_exp_f32 v33, v33
    v_exp_f32 v34, v34
    v_exp_f32 v35, v35
    v_exp_f32 v36, v36
    v_exp_f32 v37, v37
    v_exp_f32 v38, v38
    v_exp_f32 v39, v39
    v_exp_f32 v40, v40
    v_exp_f32 v41, v41
    v_exp_f32 v42, v42
    v_exp_f32 v43, v43
    v_exp_f32 v44, v44
    v_exp_f32 v45, v45
    v_exp_f32 v46, v46
    v_exp_f32 v47, v47
    v_add_f32 v32, 1.0, v32
    v_add_f32 v33, 1.0, v33
    v_add_f32 v34, 1.0, v34
    v_add_f32 v35, 1.0, v35
    v_add_f32 v36, 1.0, v36
    v_add_f32 v37, 1.0, v37
    v_add_f32 v38, 1.0, v38
    v_add_f32 v39, 1.0, v39
    v_add_f32 v40, 1.0, v40
    v_add_f32 v41, 1.0, v41
    v_add_f32 v42, 1.0, v42
    v_add_f32 v43, 1.0, v43
    v_add_f32 v44, 1.0, v44
    v_add_f32 v45, 1.0, v45
    v_add_f32 v46, 1.0, v46
    v_add_f32 v47, 1.0, v47
    v_rcp_f32 v32, v32
    v_rcp_f32 v33, v33
    v_rcp_f32 v34, v34
    v_rcp_f32 v35, v35
    v_rcp_f32 v36, v36
    v_rcp_f32 v37, v37
    v_rcp_f32 v38, v38
    v_rcp_f32 v39, v39
    v_rcp_f32 v40, v40
    v_rcp_f32 v41, v41
    v_rcp_f32 v42, v42
    v_rcp_f32 v43, v43
    v_rcp_f32 v44, v44
    v_rcp_f32 v45, v45
    v_rcp_f32 v46, v46
    v_rcp_f32 v47, v47
    s_mul_i32 s61, s53, 2097152
    s_add_u32 s61, s61, 24117248
    s_lshl_b32 s62, s58, 1
    s_and_b32 s63, s52, 1
    s_add_u32 s62, s62, s63
    s_mul_i32 s62, s62, 98304
    s_add_u32 s61, s61, s62
    s_lshl_b32 s62, s59, 1
    s_lshr_b32 s63, s52, 1
    s_add_u32 s62, s62, s63
    s_lshl_b32 s62, s62, 10
    s_add_u32 s61, s61, s62
    v_bfe_u32 v2, v0, 4, 1
    v_mul_u32_u24 v2, 49152, v2
    v_and_b32 v3, 15, v0
    v_lshl_add_u32 v2, v3, 4, v2
    v_lshrrev_b32 v3, 5, v0
    v_lshl_add_u32 v2, v3, 8, v2
    v_pk_mul_f32 v[32:33], v[32:33], v[16:17]
    v_pk_mul_f32 v[34:35], v[34:35], v[18:19]
    v_pk_mul_f32 v[36:37], v[36:37], v[20:21]
    v_pk_mul_f32 v[38:39], v[38:39], v[22:23]
    v_pk_mul_f32 v[40:41], v[40:41], v[24:25]
    v_pk_mul_f32 v[42:43], v[42:43], v[26:27]
    v_pk_mul_f32 v[44:45], v[44:45], v[28:29]
    v_pk_mul_f32 v[46:47], v[46:47], v[30:31]
    v_cvt_pk_bf16_f32 v48, v32, v33
    v_cvt_pk_bf16_f32 v49, v34, v35
    v_cvt_pk_bf16_f32 v50, v36, v37
    v_cvt_pk_bf16_f32 v51, v38, v39
    v_cvt_pk_bf16_f32 v52, v40, v41
    v_cvt_pk_bf16_f32 v53, v42, v43
    v_cvt_pk_bf16_f32 v54, v44, v45
    v_cvt_pk_bf16_f32 v55, v46, v47
    buffer_store_dwordx4 v[48:51], v2, s[40:43], s61 offen sc1
    buffer_store_dwordx4 v[52:55], v2, s[40:43], s61 offen offset:512 sc1
    s_mul_i32 s63, s57, 5
    s_lshr_b32 s63, s63, 2
    v_lshrrev_b32 v12, 5, v0
    v_lshlrev_b32 v12, 7, v12
    v_and_b32 v9, 31, v0
    v_min_u32 v9, 23, v9
    v_lshl_add_u32 v240, v9, 2, v12
    s_lshl_b32 s69, s53, 16
    s_add_u32 s69, s69, 36667392
    s_lshl_b32 s68, s63, 7
    s_add_u32 s69, s69, s68
    s_lshl_b32 s68, s100, 11
    s_add_u32 s69, s69, s68
    s_lshl_b32 s101, s53, 16
    s_add_u32 s101, s101, 36667392
    s_lshl_b32 s68, s58, 7
    s_add_u32 s101, s101, s68
    s_lshl_b32 s68, s59, 2
    s_add_u32 s101, s101, s68
    v_lshlrev_b32 v1, 11, v0
    s_waitcnt vmcnt(0)
    s_barrier
    s_cmp_lg_u32 s52, 0
    s_cbranch_scc1 W0_24
    s_mov_b64 exec, 255
    buffer_atomic_swap v243, v1, s[40:43], s101 offen sc1
    s_mov_b64 exec, -1
W0_24:
    s_branch G1DONE_25
NOG1_21:
    s_mul_i32 s63, s57, 5
    s_lshr_b32 s63, s63, 2
    v_lshrrev_b32 v12, 5, v0
    v_lshlrev_b32 v12, 7, v12
    v_and_b32 v9, 31, v0
    v_min_u32 v9, 23, v9
    v_lshl_add_u32 v240, v9, 2, v12
    s_lshl_b32 s69, s53, 16
    s_add_u32 s69, s69, 36667392
    s_lshl_b32 s68, s63, 7
    s_add_u32 s69, s69, s68
    s_lshl_b32 s68, s100, 11
    s_add_u32 s69, s69, s68
    s_lshl_b32 s101, s53, 16
    s_add_u32 s101, s101, 36667392
    s_lshl_b32 s68, s58, 7
    s_add_u32 s101, s101, s68
    s_lshl_b32 s68, s59, 2
    s_add_u32 s101, s101, s68
    s_waitcnt vmcnt(0)
    s_barrier
G1DONE_25:
    v_lshrrev_b32 v2, 5, v0
    v_bfe_u32 v3, v0, 2, 3
    v_lshl_add_u32 v2, v2, 4, v3
    v_lshlrev_b32 v2, 7, v2
    s_mul_i32 s61, s52, 40960
    v_add_u32 v2, s61, v2
    v_and_b32 v3, 1, v0
    v_lshl_add_u32 v2, v3, 3, v2
    v_bfe_u32 v3, v0, 1, 1
    v_lshl_add_u32 v2, v3, 4, v2
    v_bfe_u32 v3, v0, 3, 2
    v_xor_b32 v3, s52, v3
    v_xor_b32 v8, 0, v3
    v_lshl_add_u32 v4, v8, 5, v2
    v_xor_b32 v8, 1, v3
    v_lshl_add_u32 v5, v8, 5, v2
    v_xor_b32 v8, 2, v3
    v_lshl_add_u32 v6, v8, 5, v2
    v_xor_b32 v8, 3, v3
    v_lshl_add_u32 v7, v8, 5, v2
    ds_read_b64_tr_b16 v[196:197], v4 offset:0
    ds_read_b64_tr_b16 v[198:199], v4 offset:1024
    ds_read_b64_tr_b16 v[200:201], v5 offset:0
    ds_read_b64_tr_b16 v[202:203], v5 offset:1024
    ds_read_b64_tr_b16 v[204:205], v6 offset:0
    ds_read_b64_tr_b16 v[206:207], v6 offset:1024
    ds_read_b64_tr_b16 v[208:209], v7 offset:0
    ds_read_b64_tr_b16 v[210:211], v7 offset:1024
    ds_read_b64_tr_b16 v[212:213], v4 offset:4096
    ds_read_b64_tr_b16 v[214:215], v4 offset:5120
    ds_read_b64_tr_b16 v[216:217], v5 offset:4096
    ds_read_b64_tr_b16 v[218:219], v5 offset:5120
    ds_read_b64_tr_b16 v[220:221], v6 offset:4096
    ds_read_b64_tr_b16 v[222:223], v6 offset:5120
    ds_read_b64_tr_b16 v[224:225], v7 offset:4096
    ds_read_b64_tr_b16 v[226:227], v7 offset:5120
    s_waitcnt lgkmcnt(0)
    s_mul_i32 s61, s52, 1572864
    s_lshl_b32 s62, s56, 7
    s_add_u32 s61, s61, s62
    s_mul_i32 s62, s52, 40960
    s_add_u32 m0, s62, 28672
    s_add_u32 s63, s61, 917504
    buffer_load_dwordx4 v228, s[20:23], s63 offen lds
    s_add_u32 m0, s62, 29696
    s_add_u32 s63, s61, 950272
    buffer_load_dwordx4 v228, s[20:23], s63 offen lds
    s_add_u32 m0, s62, 30720
    s_add_u32 s63, s61, 983040
    buffer_load_dwordx4 v228, s[20:23], s63 offen lds
    s_add_u32 m0, s62, 31744
    s_add_u32 s63, s61, 1015808
    buffer_load_dwordx4 v228, s[20:23], s63 offen lds
    s_add_u32 m0, s62, 32768
    s_add_u32 s63, s61, 1048576
    buffer_load_dwordx4 v228, s[20:23], s63 offen lds
    s_add_u32 m0, s62, 33792
    s_add_u32 s63, s61, 1081344
    buffer_load_dwordx4 v228, s[20:23], s63 offen lds
    s_add_u32 m0, s62, 34816
    s_add_u32 s63, s61, 1114112
    buffer_load_dwordx4 v228, s[20:23], s63 offen lds
    s_add_u32 m0, s62, 35840
    s_add_u32 s63, s61, 1146880
    buffer_load_dwordx4 v228, s[20:23], s63 offen lds
    s_add_u32 m0, s62, 36864
    s_add_u32 s63, s61, 1179648
    buffer_load_dwordx4 v228, s[20:23], s63 offen lds
    s_add_u32 m0, s62, 37888
    s_add_u32 s63, s61, 1212416
    buffer_load_dwordx4 v228, s[20:23], s63 offen lds
    s_add_u32 m0, s62, 38912
    s_add_u32 s63, s61, 1245184
    buffer_load_dwordx4 v228, s[20:23], s63 offen lds
    s_add_u32 m0, s62, 39936
    s_add_u32 s63, s61, 1277952
    buffer_load_dwordx4 v228, s[20:23], s63 offen lds
    s_add_u32 m0, s62, 0
    s_add_u32 s63, s61, 1310720
    buffer_load_dwordx4 v228, s[20:23], s63 offen lds
    s_add_u32 m0, s62, 1024
    s_add_u32 s63, s61, 1343488
    buffer_load_dwordx4 v228, s[20:23], s63 offen lds
    s_add_u32 m0, s62, 2048
    s_add_u32 s63, s61, 1376256
    buffer_load_dwordx4 v228, s[20:23], s63 offen lds
    s_add_u32 m0, s62, 3072
    s_add_u32 s63, s61, 1409024
    buffer_load_dwordx4 v228, s[20:23], s63 offen lds
    s_add_u32 m0, s62, 4096
    s_add_u32 s63, s61, 1441792
    buffer_load_dwordx4 v228, s[20:23], s63 offen lds
    s_add_u32 m0, s62, 5120
    s_add_u32 s63, s61, 1474560
    buffer_load_dwordx4 v228, s[20:23], s63 offen lds
    s_add_u32 m0, s62, 6144
    s_add_u32 s63, s61, 1507328
    buffer_load_dwordx4 v228, s[20:23], s63 offen lds
    s_add_u32 m0, s62, 7168
    s_add_u32 s63, s61, 1540096
    buffer_load_dwordx4 v228, s[20:23], s63 offen lds
    s_mul_i32 s61, s53, 2097152
    s_add_u32 s61, s61, 24117248
    s_mul_i32 s62, s57, 245760
    s_add_u32 s61, s61, s62
    s_mul_i32 s62, s52, 12288
    s_add_u32 s61, s61, s62
    s_add_u32 s62, s61, 49152
    s_add_u32 s63, s62, 49152
    s_add_u32 s64, s63, 49152
    s_add_u32 s65, s64, 49152
    v_lshlrev_b32 v9, 4, v0
    v_add_u32 v10, 4096, v9
    v_add_u32 v11, 8192, v9
    s_cmp_lg_u32 s52, 0
    s_cbranch_scc1 W0_26
    s_mov_b32 s82, 4194304
FW_27:
    buffer_load_dword v1, v240, s[40:43], s69 offen sc1
    s_sub_u32 s82, s82, 1
    s_cbranch_scc1 L_exit
    s_waitcnt vmcnt(0)
    v_cmp_ne_u32 vcc, s99, v1
    s_cbranch_vccnz FW_27
W0_26:
    s_barrier
    buffer_load_dwordx4 v[96:99], v9, s[40:43], s61 offen offset:0
    buffer_load_dwordx4 v[100:103], v9, s[40:43], s62 offen offset:0
    buffer_load_dwordx4 v[104:107], v9, s[40:43], s63 offen offset:0
    buffer_load_dwordx4 v[108:111], v9, s[40:43], s64 offen offset:0
    buffer_load_dwordx4 v[112:115], v9, s[40:43], s65 offen offset:0
    buffer_load_dwordx4 v[116:119], v9, s[40:43], s61 offen offset:1024
    buffer_load_dwordx4 v[120:123], v9, s[40:43], s62 offen offset:1024
    buffer_load_dwordx4 v[124:127], v9, s[40:43], s63 offen offset:1024
    buffer_load_dwordx4 v[128:131], v9, s[40:43], s64 offen offset:1024
    buffer_load_dwordx4 v[132:135], v9, s[40:43], s65 offen offset:1024
    buffer_load_dwordx4 v[136:139], v9, s[40:43], s61 offen offset:2048
    buffer_load_dwordx4 v[140:143], v9, s[40:43], s62 offen offset:2048
    buffer_load_dwordx4 v[144:147], v9, s[40:43], s63 offen offset:2048
    buffer_load_dwordx4 v[148:151], v9, s[40:43], s64 offen offset:2048
    buffer_load_dwordx4 v[152:155], v9, s[40:43], s65 offen offset:2048
    buffer_load_dwordx4 v[156:159], v9, s[40:43], s61 offen offset:3072
    buffer_load_dwordx4 v[160:163], v9, s[40:43], s62 offen offset:3072
    buffer_load_dwordx4 v[164:167], v9, s[40:43], s63 offen offset:3072
    buffer_load_dwordx4 v[168:171], v9, s[40:43], s64 offen offset:3072
    buffer_load_dwordx4 v[172:175], v9, s[40:43], s65 offen offset:3072
    buffer_load_dwordx4 v[176:179], v10, s[40:43], s61 offen offset:0
    buffer_load_dwordx4 v[180:183], v10, s[40:43], s62 offen offset:0
    buffer_load_dwordx4 v[184:187], v10, s[40:43], s63 offen offset:0
    buffer_load_dwordx4 v[188:191], v10, s[40:43], s64 offen offset:0
    buffer_load_dwordx4 v[192:195], v10, s[40:43], s65 offen offset:0
    s_waitcnt vmcnt(20)
    v_mfma_f32_16x16x32_bf16 v[16:19], v[96:99], v[196:199], 0
    v_mfma_f32_16x16x32_bf16 v[32:35], v[100:103], v[196:199], 0
    v_mfma_f32_16x16x32_bf16 v[48:51], v[104:107], v[196:199], 0
    v_mfma_f32_16x16x32_bf16 v[64:67], v[108:111], v[196:199], 0
    v_mfma_f32_16x16x32_bf16 v[80:83], v[112:115], v[196:199], 0
    v_mfma_f32_16x16x32_bf16 v[20:23], v[96:99], v[200:203], 0
    v_mfma_f32_16x16x32_bf16 v[36:39], v[100:103], v[200:203], 0
    v_mfma_f32_16x16x32_bf16 v[52:55], v[104:107], v[200:203], 0
    v_mfma_f32_16x16x32_bf16 v[68:71], v[108:111], v[200:203], 0
    v_mfma_f32_16x16x32_bf16 v[84:87], v[112:115], v[200:203], 0
    v_mfma_f32_16x16x32_bf16 v[24:27], v[96:99], v[204:207], 0
    v_mfma_f32_16x16x32_bf16 v[40:43], v[100:103], v[204:207], 0
    v_mfma_f32_16x16x32_bf16 v[56:59], v[104:107], v[204:207], 0
    v_mfma_f32_16x16x32_bf16 v[72:75], v[108:111], v[204:207], 0
    v_mfma_f32_16x16x32_bf16 v[88:91], v[112:115], v[204:207], 0
    v_mfma_f32_16x16x32_bf16 v[28:31], v[96:99], v[208:211], 0
    v_mfma_f32_16x16x32_bf16 v[44:47], v[100:103], v[208:211], 0
    v_mfma_f32_16x16x32_bf16 v[60:63], v[104:107], v[208:211], 0
    v_mfma_f32_16x16x32_bf16 v[76:79], v[108:111], v[208:211], 0
    v_mfma_f32_16x16x32_bf16 v[92:95], v[112:115], v[208:211], 0
    buffer_load_dwordx4 v[96:99], v10, s[40:43], s61 offen offset:1024
    buffer_load_dwordx4 v[100:103], v10, s[40:43], s62 offen offset:1024
    buffer_load_dwordx4 v[104:107], v10, s[40:43], s63 offen offset:1024
    buffer_load_dwordx4 v[108:111], v10, s[40:43], s64 offen offset:1024
    buffer_load_dwordx4 v[112:115], v10, s[40:43], s65 offen offset:1024
    ds_read_b64_tr_b16 v[196:197], v4 offset:8192
    ds_read_b64_tr_b16 v[198:199], v4 offset:9216
    ds_read_b64_tr_b16 v[200:201], v5 offset:8192
    ds_read_b64_tr_b16 v[202:203], v5 offset:9216
    ds_read_b64_tr_b16 v[204:205], v6 offset:8192
    ds_read_b64_tr_b16 v[206:207], v6 offset:9216
    ds_read_b64_tr_b16 v[208:209], v7 offset:8192
    ds_read_b64_tr_b16 v[210:211], v7 offset:9216
    s_waitcnt vmcnt(20)
    v_mfma_f32_16x16x32_bf16 v[16:19], v[116:119], v[212:215], v[16:19]
    v_mfma_f32_16x16x32_bf16 v[32:35], v[120:123], v[212:215], v[32:35]
    v_mfma_f32_16x16x32_bf16 v[48:51], v[124:127], v[212:215], v[48:51]
    v_mfma_f32_16x16x32_bf16 v[64:67], v[128:131], v[212:215], v[64:67]
    v_mfma_f32_16x16x32_bf16 v[80:83], v[132:135], v[212:215], v[80:83]
    v_mfma_f32_16x16x32_bf16 v[20:23], v[116:119], v[216:219], v[20:23]
    v_mfma_f32_16x16x32_bf16 v[36:39], v[120:123], v[216:219], v[36:39]
    v_mfma_f32_16x16x32_bf16 v[52:55], v[124:127], v[216:219], v[52:55]
    v_mfma_f32_16x16x32_bf16 v[68:71], v[128:131], v[216:219], v[68:71]
    v_mfma_f32_16x16x32_bf16 v[84:87], v[132:135], v[216:219], v[84:87]
    v_mfma_f32_16x16x32_bf16 v[24:27], v[116:119], v[220:223], v[24:27]
    v_mfma_f32_16x16x32_bf16 v[40:43], v[120:123], v[220:223], v[40:43]
    v_mfma_f32_16x16x32_bf16 v[56:59], v[124:127], v[220:223], v[56:59]
    v_mfma_f32_16x16x32_bf16 v[72:75], v[128:131], v[220:223], v[72:75]
    v_mfma_f32_16x16x32_bf16 v[88:91], v[132:135], v[220:223], v[88:91]
    v_mfma_f32_16x16x32_bf16 v[28:31], v[116:119], v[224:227], v[28:31]
    v_mfma_f32_16x16x32_bf16 v[44:47], v[120:123], v[224:227], v[44:47]
    v_mfma_f32_16x16x32_bf16 v[60:63], v[124:127], v[224:227], v[60:63]
    v_mfma_f32_16x16x32_bf16 v[76:79], v[128:131], v[224:227], v[76:79]
    v_mfma_f32_16x16x32_bf16 v[92:95], v[132:135], v[224:227], v[92:95]
    buffer_load_dwordx4 v[116:119], v10, s[40:43], s61 offen offset:2048
    buffer_load_dwordx4 v[120:123], v10, s[40:43], s62 offen offset:2048
    buffer_load_dwordx4 v[124:127], v10, s[40:43], s63 offen offset:2048
    buffer_load_dwordx4 v[128:131], v10, s[40:43], s64 offen offset:2048
    buffer_load_dwordx4 v[132:135], v10, s[40:43], s65 offen offset:2048
    ds_read_b64_tr_b16 v[212:213], v4 offset:12288
    ds_read_b64_tr_b16 v[214:215], v4 offset:13312
    ds_read_b64_tr_b16 v[216:217], v5 offset:12288
    ds_read_b64_tr_b16 v[218:219], v5 offset:13312
    ds_read_b64_tr_b16 v[220:221], v6 offset:12288
    ds_read_b64_tr_b16 v[222:223], v6 offset:13312
    ds_read_b64_tr_b16 v[224:225], v7 offset:12288
    ds_read_b64_tr_b16 v[226:227], v7 offset:13312
    s_waitcnt vmcnt(20)
    s_waitcnt lgkmcnt(8)
    v_mfma_f32_16x16x32_bf16 v[16:19], v[136:139], v[196:199], v[16:19]
    v_mfma_f32_16x16x32_bf16 v[32:35], v[140:143], v[196:199], v[32:35]
    v_mfma_f32_16x16x32_bf16 v[48:51], v[144:147], v[196:199], v[48:51]
    v_mfma_f32_16x16x32_bf16 v[64:67], v[148:151], v[196:199], v[64:67]
    v_mfma_f32_16x16x32_bf16 v[80:83], v[152:155], v[196:199], v[80:83]
    v_mfma_f32_16x16x32_bf16 v[20:23], v[136:139], v[200:203], v[20:23]
    v_mfma_f32_16x16x32_bf16 v[36:39], v[140:143], v[200:203], v[36:39]
    v_mfma_f32_16x16x32_bf16 v[52:55], v[144:147], v[200:203], v[52:55]
    v_mfma_f32_16x16x32_bf16 v[68:71], v[148:151], v[200:203], v[68:71]
    v_mfma_f32_16x16x32_bf16 v[84:87], v[152:155], v[200:203], v[84:87]
    v_mfma_f32_16x16x32_bf16 v[24:27], v[136:139], v[204:207], v[24:27]
    v_mfma_f32_16x16x32_bf16 v[40:43], v[140:143], v[204:207], v[40:43]
    v_mfma_f32_16x16x32_bf16 v[56:59], v[144:147], v[204:207], v[56:59]
    v_mfma_f32_16x16x32_bf16 v[72:75], v[148:151], v[204:207], v[72:75]
    v_mfma_f32_16x16x32_bf16 v[88:91], v[152:155], v[204:207], v[88:91]
    v_mfma_f32_16x16x32_bf16 v[28:31], v[136:139], v[208:211], v[28:31]
    v_mfma_f32_16x16x32_bf16 v[44:47], v[140:143], v[208:211], v[44:47]
    v_mfma_f32_16x16x32_bf16 v[60:63], v[144:147], v[208:211], v[60:63]
    v_mfma_f32_16x16x32_bf16 v[76:79], v[148:151], v[208:211], v[76:79]
    v_mfma_f32_16x16x32_bf16 v[92:95], v[152:155], v[208:211], v[92:95]
    buffer_load_dwordx4 v[136:139], v10, s[40:43], s61 offen offset:3072
    buffer_load_dwordx4 v[140:143], v10, s[40:43], s62 offen offset:3072
    buffer_load_dwordx4 v[144:147], v10, s[40:43], s63 offen offset:3072
    buffer_load_dwordx4 v[148:151], v10, s[40:43], s64 offen offset:3072
    buffer_load_dwordx4 v[152:155], v10, s[40:43], s65 offen offset:3072
    ds_read_b64_tr_b16 v[196:197], v4 offset:16384
    ds_read_b64_tr_b16 v[198:199], v4 offset:17408
    ds_read_b64_tr_b16 v[200:201], v5 offset:16384
    ds_read_b64_tr_b16 v[202:203], v5 offset:17408
    ds_read_b64_tr_b16 v[204:205], v6 offset:16384
    ds_read_b64_tr_b16 v[206:207], v6 offset:17408
    ds_read_b64_tr_b16 v[208:209], v7 offset:16384
    ds_read_b64_tr_b16 v[210:211], v7 offset:17408
    s_waitcnt vmcnt(20)
    s_waitcnt lgkmcnt(8)
    v_mfma_f32_16x16x32_bf16 v[16:19], v[156:159], v[212:215], v[16:19]
    v_mfma_f32_16x16x32_bf16 v[32:35], v[160:163], v[212:215], v[32:35]
    v_mfma_f32_16x16x32_bf16 v[48:51], v[164:167], v[212:215], v[48:51]
    v_mfma_f32_16x16x32_bf16 v[64:67], v[168:171], v[212:215], v[64:67]
    v_mfma_f32_16x16x32_bf16 v[80:83], v[172:175], v[212:215], v[80:83]
    v_mfma_f32_16x16x32_bf16 v[20:23], v[156:159], v[216:219], v[20:23]
    v_mfma_f32_16x16x32_bf16 v[36:39], v[160:163], v[216:219], v[36:39]
    v_mfma_f32_16x16x32_bf16 v[52:55], v[164:167], v[216:219], v[52:55]
    v_mfma_f32_16x16x32_bf16 v[68:71], v[168:171], v[216:219], v[68:71]
    v_mfma_f32_16x16x32_bf16 v[84:87], v[172:175], v[216:219], v[84:87]
    v_mfma_f32_16x16x32_bf16 v[24:27], v[156:159], v[220:223], v[24:27]
    v_mfma_f32_16x16x32_bf16 v[40:43], v[160:163], v[220:223], v[40:43]
    v_mfma_f32_16x16x32_bf16 v[56:59], v[164:167], v[220:223], v[56:59]
    v_mfma_f32_16x16x32_bf16 v[72:75], v[168:171], v[220:223], v[72:75]
    v_mfma_f32_16x16x32_bf16 v[88:91], v[172:175], v[220:223], v[88:91]
    v_mfma_f32_16x16x32_bf16 v[28:31], v[156:159], v[224:227], v[28:31]
    v_mfma_f32_16x16x32_bf16 v[44:47], v[160:163], v[224:227], v[44:47]
    v_mfma_f32_16x16x32_bf16 v[60:63], v[164:167], v[224:227], v[60:63]
    v_mfma_f32_16x16x32_bf16 v[76:79], v[168:171], v[224:227], v[76:79]
    v_mfma_f32_16x16x32_bf16 v[92:95], v[172:175], v[224:227], v[92:95]
    buffer_load_dwordx4 v[156:159], v11, s[40:43], s61 offen offset:0
    buffer_load_dwordx4 v[160:163], v11, s[40:43], s62 offen offset:0
    buffer_load_dwordx4 v[164:167], v11, s[40:43], s63 offen offset:0
    buffer_load_dwordx4 v[168:171], v11, s[40:43], s64 offen offset:0
    buffer_load_dwordx4 v[172:175], v11, s[40:43], s65 offen offset:0
    ds_read_b64_tr_b16 v[212:213], v4 offset:20480
    ds_read_b64_tr_b16 v[214:215], v4 offset:21504
    ds_read_b64_tr_b16 v[216:217], v5 offset:20480
    ds_read_b64_tr_b16 v[218:219], v5 offset:21504
    ds_read_b64_tr_b16 v[220:221], v6 offset:20480
    ds_read_b64_tr_b16 v[222:223], v6 offset:21504
    ds_read_b64_tr_b16 v[224:225], v7 offset:20480
    ds_read_b64_tr_b16 v[226:227], v7 offset:21504
    s_waitcnt vmcnt(20)
    s_waitcnt lgkmcnt(8)
    v_mfma_f32_16x16x32_bf16 v[16:19], v[176:179], v[196:199], v[16:19]
    v_mfma_f32_16x16x32_bf16 v[32:35], v[180:183], v[196:199], v[32:35]
    v_mfma_f32_16x16x32_bf16 v[48:51], v[184:187], v[196:199], v[48:51]
    v_mfma_f32_16x16x32_bf16 v[64:67], v[188:191], v[196:199], v[64:67]
    v_mfma_f32_16x16x32_bf16 v[80:83], v[192:195], v[196:199], v[80:83]
    v_mfma_f32_16x16x32_bf16 v[20:23], v[176:179], v[200:203], v[20:23]
    v_mfma_f32_16x16x32_bf16 v[36:39], v[180:183], v[200:203], v[36:39]
    v_mfma_f32_16x16x32_bf16 v[52:55], v[184:187], v[200:203], v[52:55]
    v_mfma_f32_16x16x32_bf16 v[68:71], v[188:191], v[200:203], v[68:71]
    v_mfma_f32_16x16x32_bf16 v[84:87], v[192:195], v[200:203], v[84:87]
    v_mfma_f32_16x16x32_bf16 v[24:27], v[176:179], v[204:207], v[24:27]
    v_mfma_f32_16x16x32_bf16 v[40:43], v[180:183], v[204:207], v[40:43]
    v_mfma_f32_16x16x32_bf16 v[56:59], v[184:187], v[204:207], v[56:59]
    v_mfma_f32_16x16x32_bf16 v[72:75], v[188:191], v[204:207], v[72:75]
    v_mfma_f32_16x16x32_bf16 v[88:91], v[192:195], v[204:207], v[88:91]
    v_mfma_f32_16x16x32_bf16 v[28:31], v[176:179], v[208:211], v[28:31]
    v_mfma_f32_16x16x32_bf16 v[44:47], v[180:183], v[208:211], v[44:47]
    v_mfma_f32_16x16x32_bf16 v[60:63], v[184:187], v[208:211], v[60:63]
    v_mfma_f32_16x16x32_bf16 v[76:79], v[188:191], v[208:211], v[76:79]
    v_mfma_f32_16x16x32_bf16 v[92:95], v[192:195], v[208:211], v[92:95]
    buffer_load_dwordx4 v[176:179], v11, s[40:43], s61 offen offset:1024
    buffer_load_dwordx4 v[180:183], v11, s[40:43], s62 offen offset:1024
    buffer_load_dwordx4 v[184:187], v11, s[40:43], s63 offen offset:1024
    buffer_load_dwordx4 v[188:191], v11, s[40:43], s64 offen offset:1024
    buffer_load_dwordx4 v[192:195], v11, s[40:43], s65 offen offset:1024
    ds_read_b64_tr_b16 v[196:197], v4 offset:24576
    ds_read_b64_tr_b16 v[198:199], v4 offset:25600
    ds_read_b64_tr_b16 v[200:201], v5 offset:24576
    ds_read_b64_tr_b16 v[202:203], v5 offset:25600
    ds_read_b64_tr_b16 v[204:205], v6 offset:24576
    ds_read_b64_tr_b16 v[206:207], v6 offset:25600
    ds_read_b64_tr_b16 v[208:209], v7 offset:24576
    ds_read_b64_tr_b16 v[210:211], v7 offset:25600
    s_waitcnt vmcnt(20)
    s_waitcnt lgkmcnt(8)
    v_mfma_f32_16x16x32_bf16 v[16:19], v[96:99], v[212:215], v[16:19]
    v_mfma_f32_16x16x32_bf16 v[32:35], v[100:103], v[212:215], v[32:35]
    v_mfma_f32_16x16x32_bf16 v[48:51], v[104:107], v[212:215], v[48:51]
    v_mfma_f32_16x16x32_bf16 v[64:67], v[108:111], v[212:215], v[64:67]
    v_mfma_f32_16x16x32_bf16 v[80:83], v[112:115], v[212:215], v[80:83]
    v_mfma_f32_16x16x32_bf16 v[20:23], v[96:99], v[216:219], v[20:23]
    v_mfma_f32_16x16x32_bf16 v[36:39], v[100:103], v[216:219], v[36:39]
    v_mfma_f32_16x16x32_bf16 v[52:55], v[104:107], v[216:219], v[52:55]
    v_mfma_f32_16x16x32_bf16 v[68:71], v[108:111], v[216:219], v[68:71]
    v_mfma_f32_16x16x32_bf16 v[84:87], v[112:115], v[216:219], v[84:87]
    v_mfma_f32_16x16x32_bf16 v[24:27], v[96:99], v[220:223], v[24:27]
    v_mfma_f32_16x16x32_bf16 v[40:43], v[100:103], v[220:223], v[40:43]
    v_mfma_f32_16x16x32_bf16 v[56:59], v[104:107], v[220:223], v[56:59]
    v_mfma_f32_16x16x32_bf16 v[72:75], v[108:111], v[220:223], v[72:75]
    v_mfma_f32_16x16x32_bf16 v[88:91], v[112:115], v[220:223], v[88:91]
    v_mfma_f32_16x16x32_bf16 v[28:31], v[96:99], v[224:227], v[28:31]
    v_mfma_f32_16x16x32_bf16 v[44:47], v[100:103], v[224:227], v[44:47]
    v_mfma_f32_16x16x32_bf16 v[60:63], v[104:107], v[224:227], v[60:63]
    v_mfma_f32_16x16x32_bf16 v[76:79], v[108:111], v[224:227], v[76:79]
    v_mfma_f32_16x16x32_bf16 v[92:95], v[112:115], v[224:227], v[92:95]
    buffer_load_dwordx4 v[96:99], v11, s[40:43], s61 offen offset:2048
    buffer_load_dwordx4 v[100:103], v11, s[40:43], s62 offen offset:2048
    buffer_load_dwordx4 v[104:107], v11, s[40:43], s63 offen offset:2048
    buffer_load_dwordx4 v[108:111], v11, s[40:43], s64 offen offset:2048
    buffer_load_dwordx4 v[112:115], v11, s[40:43], s65 offen offset:2048
    ds_read_b64_tr_b16 v[212:213], v4 offset:28672
    ds_read_b64_tr_b16 v[214:215], v4 offset:29696
    ds_read_b64_tr_b16 v[216:217], v5 offset:28672
    ds_read_b64_tr_b16 v[218:219], v5 offset:29696
    ds_read_b64_tr_b16 v[220:221], v6 offset:28672
    ds_read_b64_tr_b16 v[222:223], v6 offset:29696
    ds_read_b64_tr_b16 v[224:225], v7 offset:28672
    ds_read_b64_tr_b16 v[226:227], v7 offset:29696
    s_waitcnt vmcnt(20)
    s_waitcnt lgkmcnt(8)
    v_mfma_f32_16x16x32_bf16 v[16:19], v[116:119], v[196:199], v[16:19]
    v_mfma_f32_16x16x32_bf16 v[32:35], v[120:123], v[196:199], v[32:35]
    v_mfma_f32_16x16x32_bf16 v[48:51], v[124:127], v[196:199], v[48:51]
    v_mfma_f32_16x16x32_bf16 v[64:67], v[128:131], v[196:199], v[64:67]
    v_mfma_f32_16x16x32_bf16 v[80:83], v[132:135], v[196:199], v[80:83]
    v_mfma_f32_16x16x32_bf16 v[20:23], v[116:119], v[200:203], v[20:23]
    v_mfma_f32_16x16x32_bf16 v[36:39], v[120:123], v[200:203], v[36:39]
    v_mfma_f32_16x16x32_bf16 v[52:55], v[124:127], v[200:203], v[52:55]
    v_mfma_f32_16x16x32_bf16 v[68:71], v[128:131], v[200:203], v[68:71]
    v_mfma_f32_16x16x32_bf16 v[84:87], v[132:135], v[200:203], v[84:87]
    v_mfma_f32_16x16x32_bf16 v[24:27], v[116:119], v[204:207], v[24:27]
    v_mfma_f32_16x16x32_bf16 v[40:43], v[120:123], v[204:207], v[40:43]
    v_mfma_f32_16x16x32_bf16 v[56:59], v[124:127], v[204:207], v[56:59]
    v_mfma_f32_16x16x32_bf16 v[72:75], v[128:131], v[204:207], v[72:75]
    v_mfma_f32_16x16x32_bf16 v[88:91], v[132:135], v[204:207], v[88:91]
    v_mfma_f32_16x16x32_bf16 v[28:31], v[116:119], v[208:211], v[28:31]
    v_mfma_f32_16x16x32_bf16 v[44:47], v[120:123], v[208:211], v[44:47]
    v_mfma_f32_16x16x32_bf16 v[60:63], v[124:127], v[208:211], v[60:63]
    v_mfma_f32_16x16x32_bf16 v[76:79], v[128:131], v[208:211], v[76:79]
    v_mfma_f32_16x16x32_bf16 v[92:95], v[132:135], v[208:211], v[92:95]
    buffer_load_dwordx4 v[116:119], v11, s[40:43], s61 offen offset:3072
    buffer_load_dwordx4 v[120:123], v11, s[40:43], s62 offen offset:3072
    buffer_load_dwordx4 v[124:127], v11, s[40:43], s63 offen offset:3072
    buffer_load_dwordx4 v[128:131], v11, s[40:43], s64 offen offset:3072
    buffer_load_dwordx4 v[132:135], v11, s[40:43], s65 offen offset:3072
    ds_read_b64_tr_b16 v[196:197], v4 offset:32768
    ds_read_b64_tr_b16 v[198:199], v4 offset:33792
    ds_read_b64_tr_b16 v[200:201], v5 offset:32768
    ds_read_b64_tr_b16 v[202:203], v5 offset:33792
    ds_read_b64_tr_b16 v[204:205], v6 offset:32768
    ds_read_b64_tr_b16 v[206:207], v6 offset:33792
    ds_read_b64_tr_b16 v[208:209], v7 offset:32768
    ds_read_b64_tr_b16 v[210:211], v7 offset:33792
    s_waitcnt vmcnt(20)
    s_waitcnt lgkmcnt(8)
    v_mfma_f32_16x16x32_bf16 v[16:19], v[136:139], v[212:215], v[16:19]
    v_mfma_f32_16x16x32_bf16 v[32:35], v[140:143], v[212:215], v[32:35]
    v_mfma_f32_16x16x32_bf16 v[48:51], v[144:147], v[212:215], v[48:51]
    v_mfma_f32_16x16x32_bf16 v[64:67], v[148:151], v[212:215], v[64:67]
    v_mfma_f32_16x16x32_bf16 v[80:83], v[152:155], v[212:215], v[80:83]
    v_mfma_f32_16x16x32_bf16 v[20:23], v[136:139], v[216:219], v[20:23]
    v_mfma_f32_16x16x32_bf16 v[36:39], v[140:143], v[216:219], v[36:39]
    v_mfma_f32_16x16x32_bf16 v[52:55], v[144:147], v[216:219], v[52:55]
    v_mfma_f32_16x16x32_bf16 v[68:71], v[148:151], v[216:219], v[68:71]
    v_mfma_f32_16x16x32_bf16 v[84:87], v[152:155], v[216:219], v[84:87]
    v_mfma_f32_16x16x32_bf16 v[24:27], v[136:139], v[220:223], v[24:27]
    v_mfma_f32_16x16x32_bf16 v[40:43], v[140:143], v[220:223], v[40:43]
    v_mfma_f32_16x16x32_bf16 v[56:59], v[144:147], v[220:223], v[56:59]
    v_mfma_f32_16x16x32_bf16 v[72:75], v[148:151], v[220:223], v[72:75]
    v_mfma_f32_16x16x32_bf16 v[88:91], v[152:155], v[220:223], v[88:91]
    v_mfma_f32_16x16x32_bf16 v[28:31], v[136:139], v[224:227], v[28:31]
    v_mfma_f32_16x16x32_bf16 v[44:47], v[140:143], v[224:227], v[44:47]
    v_mfma_f32_16x16x32_bf16 v[60:63], v[144:147], v[224:227], v[60:63]
    v_mfma_f32_16x16x32_bf16 v[76:79], v[148:151], v[224:227], v[76:79]
    v_mfma_f32_16x16x32_bf16 v[92:95], v[152:155], v[224:227], v[92:95]
    ds_read_b64_tr_b16 v[212:213], v4 offset:36864
    ds_read_b64_tr_b16 v[214:215], v4 offset:37888
    ds_read_b64_tr_b16 v[216:217], v5 offset:36864
    ds_read_b64_tr_b16 v[218:219], v5 offset:37888
    ds_read_b64_tr_b16 v[220:221], v6 offset:36864
    ds_read_b64_tr_b16 v[222:223], v6 offset:37888
    ds_read_b64_tr_b16 v[224:225], v7 offset:36864
    ds_read_b64_tr_b16 v[226:227], v7 offset:37888
    s_waitcnt vmcnt(15)
    s_waitcnt lgkmcnt(8)
    v_mfma_f32_16x16x32_bf16 v[16:19], v[156:159], v[196:199], v[16:19]
    v_mfma_f32_16x16x32_bf16 v[32:35], v[160:163], v[196:199], v[32:35]
    v_mfma_f32_16x16x32_bf16 v[48:51], v[164:167], v[196:199], v[48:51]
    v_mfma_f32_16x16x32_bf16 v[64:67], v[168:171], v[196:199], v[64:67]
    v_mfma_f32_16x16x32_bf16 v[80:83], v[172:175], v[196:199], v[80:83]
    v_mfma_f32_16x16x32_bf16 v[20:23], v[156:159], v[200:203], v[20:23]
    v_mfma_f32_16x16x32_bf16 v[36:39], v[160:163], v[200:203], v[36:39]
    v_mfma_f32_16x16x32_bf16 v[52:55], v[164:167], v[200:203], v[52:55]
    v_mfma_f32_16x16x32_bf16 v[68:71], v[168:171], v[200:203], v[68:71]
    v_mfma_f32_16x16x32_bf16 v[84:87], v[172:175], v[200:203], v[84:87]
    v_mfma_f32_16x16x32_bf16 v[24:27], v[156:159], v[204:207], v[24:27]
    v_mfma_f32_16x16x32_bf16 v[40:43], v[160:163], v[204:207], v[40:43]
    v_mfma_f32_16x16x32_bf16 v[56:59], v[164:167], v[204:207], v[56:59]
    v_mfma_f32_16x16x32_bf16 v[72:75], v[168:171], v[204:207], v[72:75]
    v_mfma_f32_16x16x32_bf16 v[88:91], v[172:175], v[204:207], v[88:91]
    v_mfma_f32_16x16x32_bf16 v[28:31], v[156:159], v[208:211], v[28:31]
    v_mfma_f32_16x16x32_bf16 v[44:47], v[160:163], v[208:211], v[44:47]
    v_mfma_f32_16x16x32_bf16 v[60:63], v[164:167], v[208:211], v[60:63]
    v_mfma_f32_16x16x32_bf16 v[76:79], v[168:171], v[208:211], v[76:79]
    v_mfma_f32_16x16x32_bf16 v[92:95], v[172:175], v[208:211], v[92:95]
    ds_read_b64_tr_b16 v[196:197], v4 offset:0
    ds_read_b64_tr_b16 v[198:199], v4 offset:1024
    ds_read_b64_tr_b16 v[200:201], v5 offset:0
    ds_read_b64_tr_b16 v[202:203], v5 offset:1024
    ds_read_b64_tr_b16 v[204:205], v6 offset:0
    ds_read_b64_tr_b16 v[206:207], v6 offset:1024
    ds_read_b64_tr_b16 v[208:209], v7 offset:0
    ds_read_b64_tr_b16 v[210:211], v7 offset:1024
    s_waitcnt vmcnt(10)
    s_waitcnt lgkmcnt(8)
    v_mfma_f32_16x16x32_bf16 v[16:19], v[176:179], v[212:215], v[16:19]
    v_mfma_f32_16x16x32_bf16 v[32:35], v[180:183], v[212:215], v[32:35]
    v_mfma_f32_16x16x32_bf16 v[48:51], v[184:187], v[212:215], v[48:51]
    v_mfma_f32_16x16x32_bf16 v[64:67], v[188:191], v[212:215], v[64:67]
    v_mfma_f32_16x16x32_bf16 v[80:83], v[192:195], v[212:215], v[80:83]
    v_mfma_f32_16x16x32_bf16 v[20:23], v[176:179], v[216:219], v[20:23]
    v_mfma_f32_16x16x32_bf16 v[36:39], v[180:183], v[216:219], v[36:39]
    v_mfma_f32_16x16x32_bf16 v[52:55], v[184:187], v[216:219], v[52:55]
    v_mfma_f32_16x16x32_bf16 v[68:71], v[188:191], v[216:219], v[68:71]
    v_mfma_f32_16x16x32_bf16 v[84:87], v[192:195], v[216:219], v[84:87]
    v_mfma_f32_16x16x32_bf16 v[24:27], v[176:179], v[220:223], v[24:27]
    v_mfma_f32_16x16x32_bf16 v[40:43], v[180:183], v[220:223], v[40:43]
    v_mfma_f32_16x16x32_bf16 v[56:59], v[184:187], v[220:223], v[56:59]
    v_mfma_f32_16x16x32_bf16 v[72:75], v[188:191], v[220:223], v[72:75]
    v_mfma_f32_16x16x32_bf16 v[88:91], v[192:195], v[220:223], v[88:91]
    v_mfma_f32_16x16x32_bf16 v[28:31], v[176:179], v[224:227], v[28:31]
    v_mfma_f32_16x16x32_bf16 v[44:47], v[180:183], v[224:227], v[44:47]
    v_mfma_f32_16x16x32_bf16 v[60:63], v[184:187], v[224:227], v[60:63]
    v_mfma_f32_16x16x32_bf16 v[76:79], v[188:191], v[224:227], v[76:79]
    v_mfma_f32_16x16x32_bf16 v[92:95], v[192:195], v[224:227], v[92:95]
    ds_read_b64_tr_b16 v[212:213], v4 offset:4096
    ds_read_b64_tr_b16 v[214:215], v4 offset:5120
    ds_read_b64_tr_b16 v[216:217], v5 offset:4096
    ds_read_b64_tr_b16 v[218:219], v5 offset:5120
    ds_read_b64_tr_b16 v[220:221], v6 offset:4096
    ds_read_b64_tr_b16 v[222:223], v6 offset:5120
    ds_read_b64_tr_b16 v[224:225], v7 offset:4096
    ds_read_b64_tr_b16 v[226:227], v7 offset:5120
    s_waitcnt vmcnt(5)
    s_waitcnt lgkmcnt(8)
    v_mfma_f32_16x16x32_bf16 v[16:19], v[96:99], v[196:199], v[16:19]
    v_mfma_f32_16x16x32_bf16 v[32:35], v[100:103], v[196:199], v[32:35]
    v_mfma_f32_16x16x32_bf16 v[48:51], v[104:107], v[196:199], v[48:51]
    v_mfma_f32_16x16x32_bf16 v[64:67], v[108:111], v[196:199], v[64:67]
    v_mfma_f32_16x16x32_bf16 v[80:83], v[112:115], v[196:199], v[80:83]
    v_mfma_f32_16x16x32_bf16 v[20:23], v[96:99], v[200:203], v[20:23]
    v_mfma_f32_16x16x32_bf16 v[36:39], v[100:103], v[200:203], v[36:39]
    v_mfma_f32_16x16x32_bf16 v[52:55], v[104:107], v[200:203], v[52:55]
    v_mfma_f32_16x16x32_bf16 v[68:71], v[108:111], v[200:203], v[68:71]
    v_mfma_f32_16x16x32_bf16 v[84:87], v[112:115], v[200:203], v[84:87]
    v_mfma_f32_16x16x32_bf16 v[24:27], v[96:99], v[204:207], v[24:27]
    v_mfma_f32_16x16x32_bf16 v[40:43], v[100:103], v[204:207], v[40:43]
    v_mfma_f32_16x16x32_bf16 v[56:59], v[104:107], v[204:207], v[56:59]
    v_mfma_f32_16x16x32_bf16 v[72:75], v[108:111], v[204:207], v[72:75]
    v_mfma_f32_16x16x32_bf16 v[88:91], v[112:115], v[204:207], v[88:91]
    v_mfma_f32_16x16x32_bf16 v[28:31], v[96:99], v[208:211], v[28:31]
    v_mfma_f32_16x16x32_bf16 v[44:47], v[100:103], v[208:211], v[44:47]
    v_mfma_f32_16x16x32_bf16 v[60:63], v[104:107], v[208:211], v[60:63]
    v_mfma_f32_16x16x32_bf16 v[76:79], v[108:111], v[208:211], v[76:79]
    v_mfma_f32_16x16x32_bf16 v[92:95], v[112:115], v[208:211], v[92:95]
    s_waitcnt vmcnt(0)
    s_waitcnt lgkmcnt(0)
    v_mfma_f32_16x16x32_bf16 v[16:19], v[116:119], v[212:215], v[16:19]
    v_mfma_f32_16x16x32_bf16 v[32:35], v[120:123], v[212:215], v[32:35]
    v_mfma_f32_16x16x32_bf16 v[48:51], v[124:127], v[212:215], v[48:51]
    v_mfma_f32_16x16x32_bf16 v[64:67], v[128:131], v[212:215], v[64:67]
    v_mfma_f32_16x16x32_bf16 v[80:83], v[132:135], v[212:215], v[80:83]
    v_mfma_f32_16x16x32_bf16 v[20:23], v[116:119], v[216:219], v[20:23]
    v_mfma_f32_16x16x32_bf16 v[36:39], v[120:123], v[216:219], v[36:39]
    v_mfma_f32_16x16x32_bf16 v[52:55], v[124:127], v[216:219], v[52:55]
    v_mfma_f32_16x16x32_bf16 v[68:71], v[128:131], v[216:219], v[68:71]
    v_mfma_f32_16x16x32_bf16 v[84:87], v[132:135], v[216:219], v[84:87]
    v_mfma_f32_16x16x32_bf16 v[24:27], v[116:119], v[220:223], v[24:27]
    v_mfma_f32_16x16x32_bf16 v[40:43], v[120:123], v[220:223], v[40:43]
    v_mfma_f32_16x16x32_bf16 v[56:59], v[124:127], v[220:223], v[56:59]
    v_mfma_f32_16x16x32_bf16 v[72:75], v[128:131], v[220:223], v[72:75]
    v_mfma_f32_16x16x32_bf16 v[88:91], v[132:135], v[220:223], v[88:91]
    v_mfma_f32_16x16x32_bf16 v[28:31], v[116:119], v[224:227], v[28:31]
    v_mfma_f32_16x16x32_bf16 v[44:47], v[120:123], v[224:227], v[44:47]
    v_mfma_f32_16x16x32_bf16 v[60:63], v[124:127], v[224:227], v[60:63]
    v_mfma_f32_16x16x32_bf16 v[76:79], v[128:131], v[224:227], v[76:79]
    v_mfma_f32_16x16x32_bf16 v[92:95], v[132:135], v[224:227], v[92:95]
    s_barrier
    s_cmp_lg_u32 s53, 0
    s_cbranch_scc1 NOWQ_28
    s_lshl_b32 s66, s52, 14
    s_mul_i32 s67, s55, 92160
    s_add_u32 s67, s67, 33554432
    s_add_u32 m0, s66, 0
    s_add_u32 s63, s67, m0
    buffer_load_dwordx4 v9, s[40:43], s63 offen offset:0 lds
    buffer_load_dwordx4 v9, s[40:43], s63 offen offset:1024 lds
    buffer_load_dwordx4 v9, s[40:43], s63 offen offset:2048 lds
    buffer_load_dwordx4 v9, s[40:43], s63 offen offset:3072 lds
    s_add_u32 m0, s66, 4096
    s_add_u32 s63, s67, m0
    buffer_load_dwordx4 v9, s[40:43], s63 offen offset:0 lds
    buffer_load_dwordx4 v9, s[40:43], s63 offen offset:1024 lds
    buffer_load_dwordx4 v9, s[40:43], s63 offen offset:2048 lds
    buffer_load_dwordx4 v9, s[40:43], s63 offen offset:3072 lds
NOWQ_28:
    v_lshlrev_b32 v4, 4, v0
    s_xor_b32 s61, s52, 1
    s_mul_i32 s61, s61, 15360
    s_add_u32 s61, s61, 102400
    v_add_u32 v5, s61, v4
    s_xor_b32 s61, s52, 2
    s_mul_i32 s61, s61, 15360
    s_add_u32 s61, s61, 107520
    v_add_u32 v6, s61, v4
    s_xor_b32 s61, s52, 3
    s_mul_i32 s61, s61, 15360
    s_add_u32 s61, s61, 112640
    v_add_u32 v7, s61, v4
    s_mul_i32 s61, s52, 15360
    s_add_u32 s61, s61, 102400
    v_add_u32 v4, s61, v4
    ds_write_b128 v5, v[20:23] offset:0
    ds_write_b128 v5, v[36:39] offset:1024
    ds_write_b128 v5, v[52:55] offset:2048
    ds_write_b128 v5, v[68:71] offset:3072
    ds_write_b128 v5, v[84:87] offset:4096
    ds_write_b128 v6, v[24:27] offset:0
    ds_write_b128 v6, v[40:43] offset:1024
    ds_write_b128 v6, v[56:59] offset:2048
    ds_write_b128 v6, v[72:75] offset:3072
    ds_write_b128 v6, v[88:91] offset:4096
    ds_write_b128 v7, v[28:31] offset:0
    ds_write_b128 v7, v[44:47] offset:1024
    ds_write_b128 v7, v[60:63] offset:2048
    ds_write_b128 v7, v[76:79] offset:3072
    ds_write_b128 v7, v[92:95] offset:4096
    s_waitcnt lgkmcnt(0)
    s_barrier
    ds_read_b128 v[112:115], v4 offset:0
    ds_read_b128 v[116:119], v4 offset:1024
    ds_read_b128 v[120:123], v4 offset:2048
    ds_read_b128 v[124:127], v4 offset:3072
    ds_read_b128 v[128:131], v4 offset:4096
    ds_read_b128 v[132:135], v4 offset:5120
    ds_read_b128 v[136:139], v4 offset:6144
    ds_read_b128 v[140:143], v4 offset:7168
    ds_read_b128 v[144:147], v4 offset:8192
    ds_read_b128 v[148:151], v4 offset:9216
    ds_read_b128 v[152:155], v4 offset:10240
    ds_read_b128 v[156:159], v4 offset:11264
    ds_read_b128 v[160:163], v4 offset:12288
    ds_read_b128 v[164:167], v4 offset:13312
    ds_read_b128 v[168:171], v4 offset:14336
    s_mov_b32 s61, 0xffff0000
    v_lshlrev_b32 v8, 16, v229
    v_lshlrev_b32 v176, 16, v246
    v_and_b32 v177, s61, v246
    v_lshlrev_b32 v178, 16, v247
    v_and_b32 v179, s61, v247
    v_lshlrev_b32 v180, 16, v248
    v_and_b32 v181, s61, v248
    v_lshlrev_b32 v182, 16, v249
    v_and_b32 v183, s61, v249
    v_lshlrev_b32 v184, 16, v250
    v_and_b32 v185, s61, v250
    v_lshlrev_b32 v186, 16, v251
    v_and_b32 v187, s61, v251
    v_lshlrev_b32 v188, 16, v252
    v_and_b32 v189, s61, v252
    v_lshlrev_b32 v190, 16, v253
    v_and_b32 v191, s61, v253
    v_lshlrev_b32 v192, 16, v254
    v_and_b32 v193, s61, v254
    v_lshlrev_b32 v194, 16, v255
    v_and_b32 v195, s61, v255
    v_pk_add_f32 v[176:177], v[176:177], v[8:9] op_sel_hi:[1,0]
    v_pk_add_f32 v[178:179], v[178:179], v[8:9] op_sel_hi:[1,0]
    v_pk_add_f32 v[180:181], v[180:181], v[8:9] op_sel_hi:[1,0]
    v_pk_add_f32 v[182:183], v[182:183], v[8:9] op_sel_hi:[1,0]
    v_pk_add_f32 v[184:185], v[184:185], v[8:9] op_sel_hi:[1,0]
    v_pk_add_f32 v[186:187], v[186:187], v[8:9] op_sel_hi:[1,0]
    v_pk_add_f32 v[188:189], v[188:189], v[8:9] op_sel_hi:[1,0]
    v_pk_add_f32 v[190:191], v[190:191], v[8:9] op_sel_hi:[1,0]
    v_pk_add_f32 v[192:193], v[192:193], v[8:9] op_sel_hi:[1,0]
    v_pk_add_f32 v[194:195], v[194:195], v[8:9] op_sel_hi:[1,0]
    v_pk_add_f32 v[176:177], v[176:177], v[16:17]
    v_pk_add_f32 v[178:179], v[178:179], v[18:19]
    v_pk_add_f32 v[180:181], v[180:181], v[32:33]
    v_pk_add_f32 v[182:183], v[182:183], v[34:35]
    v_pk_add_f32 v[184:185], v[184:185], v[48:49]
    v_pk_add_f32 v[186:187], v[186:187], v[50:51]
    v_pk_add_f32 v[188:189], v[188:189], v[64:65]
    v_pk_add_f32 v[190:191], v[190:191], v[66:67]
    v_pk_add_f32 v[192:193], v[192:193], v[80:81]
    v_pk_add_f32 v[194:195], v[194:195], v[82:83]
    s_waitcnt lgkmcnt(10)
    v_pk_add_f32 v[176:177], v[176:177], v[112:113]
    v_pk_add_f32 v[178:179], v[178:179], v[114:115]
    v_pk_add_f32 v[180:181], v[180:181], v[116:117]
    v_pk_add_f32 v[182:183], v[182:183], v[118:119]
    v_pk_add_f32 v[184:185], v[184:185], v[120:121]
    v_pk_add_f32 v[186:187], v[186:187], v[122:123]
    v_pk_add_f32 v[188:189], v[188:189], v[124:125]
    v_pk_add_f32 v[190:191], v[190:191], v[126:127]
    v_pk_add_f32 v[192:193], v[192:193], v[128:129]
    v_pk_add_f32 v[194:195], v[194:195], v[130:131]
    s_waitcnt lgkmcnt(5)
    v_pk_add_f32 v[176:177], v[176:177], v[132:133]
    v_pk_add_f32 v[178:179], v[178:179], v[134:135]
    v_pk_add_f32 v[180:181], v[180:181], v[136:137]
    v_pk_add_f32 v[182:183], v[182:183], v[138:139]
    v_pk_add_f32 v[184:185], v[184:185], v[140:141]
    v_pk_add_f32 v[186:187], v[186:187], v[142:143]
    v_pk_add_f32 v[188:189], v[188:189], v[144:145]
    v_pk_add_f32 v[190:191], v[190:191], v[146:147]
    v_pk_add_f32 v[192:193], v[192:193], v[148:149]
    v_pk_add_f32 v[194:195], v[194:195], v[150:151]
    s_waitcnt lgkmcnt(0)
    v_pk_add_f32 v[176:177], v[176:177], v[152:153]
    v_pk_add_f32 v[178:179], v[178:179], v[154:155]
    v_pk_add_f32 v[180:181], v[180:181], v[156:157]
    v_pk_add_f32 v[182:183], v[182:183], v[158:159]
    v_pk_add_f32 v[184:185], v[184:185], v[160:161]
    v_pk_add_f32 v[186:187], v[186:187], v[162:163]
    v_pk_add_f32 v[188:189], v[188:189], v[164:165]
    v_pk_add_f32 v[190:191], v[190:191], v[166:167]
    v_pk_add_f32 v[192:193], v[192:193], v[168:169]
    v_pk_add_f32 v[194:195], v[194:195], v[170:171]
    s_cmp_lg_u32 s53, 0
    s_cbranch_scc1 NOWQ_29
    s_add_u32 m0, s66, 8192
    s_add_u32 s63, s67, m0
    buffer_load_dwordx4 v9, s[40:43], s63 offen offset:0 lds
    buffer_load_dwordx4 v9, s[40:43], s63 offen offset:1024 lds
    buffer_load_dwordx4 v9, s[40:43], s63 offen offset:2048 lds
    buffer_load_dwordx4 v9, s[40:43], s63 offen offset:3072 lds
    s_add_u32 m0, s66, 12288
    s_add_u32 s63, s67, m0
    buffer_load_dwordx4 v9, s[40:43], s63 offen offset:0 lds
    buffer_load_dwordx4 v9, s[40:43], s63 offen offset:1024 lds
    buffer_load_dwordx4 v9, s[40:43], s63 offen offset:2048 lds
    buffer_load_dwordx4 v9, s[40:43], s63 offen offset:3072 lds
NOWQ_29:
    v_cvt_pk_bf16_f32 v246, v176, v177
    v_cvt_pk_bf16_f32 v247, v178, v179
    v_cvt_pk_bf16_f32 v248, v180, v181
    v_cvt_pk_bf16_f32 v249, v182, v183
    v_cvt_pk_bf16_f32 v250, v184, v185
    v_cvt_pk_bf16_f32 v251, v186, v187
    v_cvt_pk_bf16_f32 v252, v188, v189
    v_cvt_pk_bf16_f32 v253, v190, v191
    v_cvt_pk_bf16_f32 v254, v192, v193
    v_cvt_pk_bf16_f32 v255, v194, v195
    s_cmp_lg_u32 s53, 0
    s_cbranch_scc1 OUT1_30
    v_and_b32 v5, 15, v0
    v_bfe_u32 v6, v0, 4, 1
    v_lshrrev_b32 v7, 5, v0
    s_lshl_b32 s61, s56, 1
    s_lshr_b32 s62, s52, 1
    s_add_u32 s61, s61, s62
    s_mul_i32 s61, s61, 40
    s_mul_i32 s62, s57, 5
    s_add_u32 s61, s61, s62
    s_lshl_b32 s61, s61, 10
    s_and_b32 s62, s52, 1
    s_lshl_b32 s62, s62, 8
    s_add_u32 s61, s61, s62
    s_add_u32 s61, s61, 30932992
    v_lshlrev_b32 v5, 4, v5
    v_lshl_add_u32 v5, v7, 9, v5
    v_lshl_add_u32 v2, v6, 10, v5
    v_add_u32 v3, 2048, v2
    v_lshl_add_u32 v4, v6, 3, v5
    v_add_u32 v4, 4096, v4
    s_branch OUT2_31
OUT1_30:
    v_and_b32 v5, 15, v0
    v_bfe_u32 v6, v0, 4, 1
    v_lshrrev_b32 v7, 5, v0
    s_lshl_b32 s61, s56, 2
    s_add_u32 s61, s61, s52
    s_mul_i32 s61, s61, 20480
    s_mul_i32 s62, s57, 160
    s_add_u32 s61, s61, s62
    v_mul_u32_u24 v5, 1280, v5
    v_lshl_add_u32 v5, v7, 4, v5
    v_lshl_add_u32 v2, v6, 5, v5
    v_add_u32 v3, 64, v2
    v_lshl_add_u32 v4, v6, 3, v5
    v_add_u32 v4, 128, v4
OUT2_31:
    v_mov_b32 v16, v246
    v_mov_b32 v17, v247
    v_mov_b32 v18, v248
    v_mov_b32 v19, v249
    v_mov_b32 v20, v250
    v_mov_b32 v21, v251
    v_mov_b32 v22, v252
    v_mov_b32 v23, v253
    buffer_store_dwordx2 v[254:255], v4, s[48:51], s61 offen sc1
    v_permlane16_swap_b32 v16, v18
    v_permlane16_swap_b32 v17, v19
    v_permlane16_swap_b32 v20, v22
    v_permlane16_swap_b32 v21, v23
    buffer_store_dwordx4 v[16:19], v2, s[48:51], s61 offen sc1
    buffer_store_dwordx4 v[20:23], v3, s[48:51], s61 offen sc1
    s_cmp_lg_u32 s53, 0
    s_cbranch_scc1 L_fin
    s_mov_b32 s61, 0xffff0000
    v_lshlrev_b32 v24, 16, v246
    v_and_b32 v25, s61, v246
    v_lshlrev_b32 v26, 16, v247
    v_and_b32 v27, s61, v247
    v_lshlrev_b32 v28, 16, v248
    v_and_b32 v29, s61, v248
    v_lshlrev_b32 v30, 16, v249
    v_and_b32 v31, s61, v249
    v_lshlrev_b32 v32, 16, v250
    v_and_b32 v33, s61, v250
    v_lshlrev_b32 v34, 16, v251
    v_and_b32 v35, s61, v251
    v_lshlrev_b32 v36, 16, v252
    v_and_b32 v37, s61, v252
    v_lshlrev_b32 v38, 16, v253
    v_and_b32 v39, s61, v253
    v_lshlrev_b32 v40, 16, v254
    v_and_b32 v41, s61, v254
    v_lshlrev_b32 v42, 16, v255
    v_and_b32 v43, s61, v255
    v_add_f32 v44, v24, v25
    v_mul_f32 v45, v24, v24
    v_fmac_f32 v45, v25, v25
    v_add_f32 v44, v44, v26
    v_fmac_f32 v45, v26, v26
    v_add_f32 v44, v44, v27
    v_fmac_f32 v45, v27, v27
    v_add_f32 v44, v44, v28
    v_fmac_f32 v45, v28, v28
    v_add_f32 v44, v44, v29
    v_fmac_f32 v45, v29, v29
    v_add_f32 v44, v44, v30
    v_fmac_f32 v45, v30, v30
    v_add_f32 v44, v44, v31
    v_fmac_f32 v45, v31, v31
    v_add_f32 v44, v44, v32
    v_fmac_f32 v45, v32, v32
    v_add_f32 v44, v44, v33
    v_fmac_f32 v45, v33, v33
    v_add_f32 v44, v44, v34
    v_fmac_f32 v45, v34, v34
    v_add_f32 v44, v44, v35
    v_fmac_f32 v45, v35, v35
    v_add_f32 v44, v44, v36
    v_fmac_f32 v45, v36, v36
    v_add_f32 v44, v44, v37
    v_fmac_f32 v45, v37, v37
    v_add_f32 v44, v44, v38
    v_fmac_f32 v45, v38, v38
    v_add_f32 v44, v44, v39
    v_fmac_f32 v45, v39, v39
    v_add_f32 v44, v44, v40
    v_fmac_f32 v45, v40, v40
    v_add_f32 v44, v44, v41
    v_fmac_f32 v45, v41, v41
    v_add_f32 v44, v44, v42
    v_fmac_f32 v45, v42, v42
    v_add_f32 v44, v44, v43
    v_fmac_f32 v45, v43, v43
    v_mov_b32 v46, v44
    s_nop 1
    v_permlane16_swap_b32 v44, v46
    v_add_f32 v44, v44, v46
    v_mov_b32 v46, v44
    s_nop 1
    v_permlane32_swap_b32 v44, v46
    v_add_f32 v44, v44, v46
    v_mov_b32 v46, v45
    s_nop 1
    v_permlane16_swap_b32 v45, v46
    v_add_f32 v45, v45, v46
    v_mov_b32 v46, v45
    s_nop 1
    v_permlane32_swap_b32 v45, v46
    v_add_f32 v45, v45, v46
    s_lshl_b32 s62, s56, 2
    s_add_u32 s62, s62, s52
    s_lshl_b32 s62, s62, 10
    v_and_b32 v47, 15, v0
    v_lshlrev_b32 v47, 6, v47
    v_add_u32 v47, s62, v47
    s_lshl_b32 s61, s57, 3
    s_add_u32 s62, s61, 196608
    s_mov_b64 exec, 0xffff
    buffer_store_dwordx2 v[44:45], v47, s[40:43], s62 offen sc1
    s_mov_b64 exec, -1
    s_mov_b32 s53, 1
    v_and_b32 v240, 31, v0
    v_lshlrev_b32 v240, 2, v240
    s_lshl_b32 s69, s53, 16
    s_add_u32 s69, s69, 36634624
    s_lshl_b32 s68, s54, 7
    s_add_u32 s69, s69, s68
    s_lshl_b32 s68, s100, 10
    s_add_u32 s69, s69, s68
    s_lshl_b32 s101, s53, 16
    s_add_u32 s101, s101, 36634624
    s_lshl_b32 s68, s56, 5
    s_add_u32 s101, s101, s68
    s_lshl_b32 s68, s57, 2
    s_add_u32 s101, s101, s68
    v_lshlrev_b32 v1, 10, v0
    s_waitcnt vmcnt(0)
    s_barrier
    s_cmp_lg_u32 s52, 0
    s_cbranch_scc1 W0_32
    s_mov_b64 exec, 255
    buffer_atomic_swap v243, v1, s[40:43], s101 offen sc1
    s_mov_b64 exec, -1
W0_32:
    s_cmp_eq_u32 s52, 0
    s_cbranch_scc1 NOWQ_33
    s_mul_i32 s66, s52, 9
    s_add_u32 s66, s66, 55
    s_min_u32 s66, s66, 81
    s_lshl_b32 s66, s66, 10
    s_add_u32 m0, s66, 0
    s_add_u32 s63, s67, m0
    buffer_load_dwordx4 v9, s[40:43], s63 offen offset:0 lds
    buffer_load_dwordx4 v9, s[40:43], s63 offen offset:1024 lds
    buffer_load_dwordx4 v9, s[40:43], s63 offen offset:2048 lds
    buffer_load_dwordx4 v9, s[40:43], s63 offen offset:3072 lds
    s_add_u32 m0, s66, 4096
    s_add_u32 s63, s67, m0
    buffer_load_dwordx4 v9, s[40:43], s63 offen offset:0 lds
    buffer_load_dwordx4 v9, s[40:43], s63 offen offset:1024 lds
    buffer_load_dwordx4 v9, s[40:43], s63 offen offset:2048 lds
    buffer_load_dwordx4 v9, s[40:43], s63 offen offset:3072 lds
    s_add_u32 m0, s66, 8192
    s_add_u32 s63, s67, m0
    buffer_load_dwordx4 v9, s[40:43], s63 offen offset:0 lds
NOWQ_33:
    s_mov_b32 s48, s32
    s_mov_b32 s49, s33
    s_mov_b32 s50, s34
    s_mov_b32 s51, s35
    s_branch L_layer
L_ev:
    s_cmp_eq_u32 s85, 6
    s_cbranch_scc1 L_ev6
    s_cmp_eq_u32 s85, 7
    s_cbranch_scc1 L_ev7
    s_cmp_eq_u32 s85, 4
    s_cselect_b32 s61, -1, 1
    s_mul_i32 s61, s61, 122880
    s_cmp_eq_u32 s85, 2
    s_cselect_b32 s62, 2, 1
    v_add_u32 v200, s61, v200
    s_add_u32 s95, s95, s62
    s_branch L_attn_loop
L_ev6:
    v_mov_b32 v200, v201
    s_mov_b32 s44, s20
    s_mov_b32 s45, s21
    s_mov_b32 s95, 7
    s_branch L_attn_loop
L_ev7:
    v_add_u32 v200, 131072, v200
    s_branch L_attn_loop
L_wev2:
    s_add_u32 s75, s96, 10240
    s_add_u32 s76, s76, 245760
    s_branch L_w_loop
L_wev3:
    ds_read_b64_tr_b16 a[0:1], v220 offset:0
    ds_read_b64_tr_b16 a[2:3], v220 offset:512
    ds_read_b64_tr_b16 a[4:5], v221 offset:0
    ds_read_b64_tr_b16 a[6:7], v221 offset:512
    ds_read_b64_tr_b16 a[8:9], v220 offset:2048
    ds_read_b64_tr_b16 a[10:11], v220 offset:2560
    ds_read_b64_tr_b16 a[12:13], v221 offset:2048
    ds_read_b64_tr_b16 a[14:15], v221 offset:2560
    ds_read_b64_tr_b16 a[16:17], v220 offset:4096
    ds_read_b64_tr_b16 a[18:19], v220 offset:4608
    ds_read_b64_tr_b16 a[20:21], v221 offset:4096
    ds_read_b64_tr_b16 a[22:23], v221 offset:4608
    ds_read_b64_tr_b16 a[24:25], v220 offset:6144
    ds_read_b64_tr_b16 a[26:27], v220 offset:6656
    ds_read_b64_tr_b16 a[28:29], v221 offset:6144
    ds_read_b64_tr_b16 a[30:31], v221 offset:6656
    ds_read_b64_tr_b16 a[32:33], v220 offset:8192
    ds_read_b64_tr_b16 a[34:35], v220 offset:8704
    ds_read_b64_tr_b16 a[36:37], v221 offset:8192
    ds_read_b64_tr_b16 a[38:39], v221 offset:8704
    s_add_u32 s75, s96, 0
    s_add_u32 s76, s76, 245760
    s_branch L_w_loop
L_wev4:
    ds_read_b64_tr_b16 a[40:41], v220 offset:10240
    ds_read_b64_tr_b16 a[42:43], v220 offset:10752
    ds_read_b64_tr_b16 a[44:45], v221 offset:10240
    ds_read_b64_tr_b16 a[46:47], v221 offset:10752
    ds_read_b64_tr_b16 a[48:49], v220 offset:12288
    ds_read_b64_tr_b16 a[50:51], v220 offset:12800
    ds_read_b64_tr_b16 a[52:53], v221 offset:12288
    ds_read_b64_tr_b16 a[54:55], v221 offset:12800
    ds_read_b64_tr_b16 a[56:57], v220 offset:14336
    ds_read_b64_tr_b16 a[58:59], v220 offset:14848
    ds_read_b64_tr_b16 a[60:61], v221 offset:14336
    ds_read_b64_tr_b16 a[62:63], v221 offset:14848
    ds_read_b64_tr_b16 a[64:65], v220 offset:16384
    ds_read_b64_tr_b16 a[66:67], v220 offset:16896
    ds_read_b64_tr_b16 a[68:69], v221 offset:16384
    ds_read_b64_tr_b16 a[70:71], v221 offset:16896
    ds_read_b64_tr_b16 a[72:73], v220 offset:18432
    ds_read_b64_tr_b16 a[74:75], v220 offset:18944
    ds_read_b64_tr_b16 a[76:77], v221 offset:18432
    ds_read_b64_tr_b16 a[78:79], v221 offset:18944
    s_add_u32 s75, s96, 10240
    s_add_u32 s76, s76, 245760
    s_branch L_w_loop
L_wev5:
    ds_read_b64_tr_b16 a[80:81], v220 offset:0
    ds_read_b64_tr_b16 a[82:83], v220 offset:512
    ds_read_b64_tr_b16 a[84:85], v221 offset:0
    ds_read_b64_tr_b16 a[86:87], v221 offset:512
    ds_read_b64_tr_b16 a[88:89], v220 offset:2048
    ds_read_b64_tr_b16 a[90:91], v220 offset:2560
    ds_read_b64_tr_b16 a[92:93], v221 offset:2048
    ds_read_b64_tr_b16 a[94:95], v221 offset:2560
    ds_read_b64_tr_b16 a[96:97], v220 offset:4096
    ds_read_b64_tr_b16 a[98:99], v220 offset:4608
    ds_read_b64_tr_b16 a[100:101], v221 offset:4096
    ds_read_b64_tr_b16 a[102:103], v221 offset:4608
    ds_read_b64_tr_b16 a[104:105], v220 offset:6144
    ds_read_b64_tr_b16 a[106:107], v220 offset:6656
    ds_read_b64_tr_b16 a[108:109], v221 offset:6144
    ds_read_b64_tr_b16 a[110:111], v221 offset:6656
    ds_read_b64_tr_b16 a[112:113], v220 offset:8192
    ds_read_b64_tr_b16 a[114:115], v220 offset:8704
    ds_read_b64_tr_b16 a[116:117], v221 offset:8192
    ds_read_b64_tr_b16 a[118:119], v221 offset:8704
    s_add_u32 s75, s96, 0
    s_add_u32 s76, s94, 0
    s_mov_b32 s36, s12
    s_mov_b32 s37, s13
    s_mov_b32 s38, s14
    s_mov_b32 s39, s15
    v_add_u32 v230, 0, v188
    v_add_u32 v231, 1024, v189
    v_add_u32 v232, 2048, v190
    v_add_u32 v233, 3072, v191
    v_add_u32 v234, 0, v192
    v_add_u32 v235, 40960, v188
    v_add_u32 v236, 41984, v189
    v_add_u32 v237, 43008, v190
    v_add_u32 v238, 44032, v191
    v_add_u32 v239, 40960, v192
    s_branch L_w_loop
L_wev6:
    ds_read_b64_tr_b16 a[120:121], v220 offset:10240
    ds_read_b64_tr_b16 a[122:123], v220 offset:10752
    ds_read_b64_tr_b16 a[124:125], v221 offset:10240
    ds_read_b64_tr_b16 a[126:127], v221 offset:10752
    ds_read_b64_tr_b16 a[128:129], v220 offset:12288
    ds_read_b64_tr_b16 a[130:131], v220 offset:12800
    ds_read_b64_tr_b16 a[132:133], v221 offset:12288
    ds_read_b64_tr_b16 a[134:135], v221 offset:12800
    ds_read_b64_tr_b16 a[136:137], v220 offset:14336
    ds_read_b64_tr_b16 a[138:139], v220 offset:14848
    ds_read_b64_tr_b16 a[140:141], v221 offset:14336
    ds_read_b64_tr_b16 a[142:143], v221 offset:14848
    ds_read_b64_tr_b16 a[144:145], v220 offset:16384
    ds_read_b64_tr_b16 a[146:147], v220 offset:16896
    ds_read_b64_tr_b16 a[148:149], v221 offset:16384
    ds_read_b64_tr_b16 a[150:151], v221 offset:16896
    ds_read_b64_tr_b16 a[152:153], v220 offset:18432
    ds_read_b64_tr_b16 a[154:155], v220 offset:18944
    ds_read_b64_tr_b16 a[156:157], v221 offset:18432
    ds_read_b64_tr_b16 a[158:159], v221 offset:18944
    s_add_u32 s75, s96, 10240
    s_add_u32 s76, s94, 81920
    v_mov_b32 v200, v201
    s_mov_b32 s44, s20
    s_mov_b32 s45, s21
    s_branch L_w_loop
L_wev7:
    s_add_u32 s75, s96, 20480
    s_add_u32 s76, s94, 163840
    v_add_u32 v200, 131072, v200
    s_branch L_attn_loop
L_slow:
    v_and_b32 v10, 31, v0
    v_lshlrev_b32 v11, 4, v10
    v_add_u32 v11, 8192, v11
    v_min_u32 v10, 20, v10
    v_lshrrev_b32 v12, 5, v0
    v_mul_u32_u24 v12, 336, v12
    v_lshl_add_u32 v12, v10, 4, v12
    v_add_u32 v12, 10240, v12
    v_mov_b32 v200, 0xff800000
    v_mov_b32 v201, 0xff800000
    s_mov_b32 s72, 0
    v_mov_b32 v80, 0
    v_mov_b32 v81, 0
    v_mov_b32 v82, 0
    v_mov_b32 v83, 0
    v_mov_b32 v84, 0
    v_mov_b32 v85, 0
    v_mov_b32 v86, 0
    v_mov_b32 v87, 0
    v_mov_b32 v88, 0
    v_mov_b32 v89, 0
    v_mov_b32 v90, 0
    v_mov_b32 v91, 0
    v_mov_b32 v92, 0
    v_mov_b32 v93, 0
    v_mov_b32 v94, 0
    v_mov_b32 v95, 0
    v_mov_b32 v96, 0
    v_mov_b32 v97, 0
    v_mov_b32 v98, 0
    v_mov_b32 v99, 0
    v_mov_b32 v100, 0
    v_mov_b32 v101, 0
    v_mov_b32 v102, 0
    v_mov_b32 v103, 0
    v_mov_b32 v104, 0
    v_mov_b32 v105, 0
    v_mov_b32 v106, 0
    v_mov_b32 v107, 0
    v_mov_b32 v108, 0
    v_mov_b32 v109, 0
    v_mov_b32 v110, 0
    v_mov_b32 v111, 0
L_sl_pass:
    s_mov_b32 s73, 0
L_sl_tile:
    s_lshr_b32 s74, s73, 3
    s_mul_i32 s74, s74, 21504
    s_add_u32 s74, s74, s80
    s_and_b32 s75, s73, 7
    s_lshl_b32 s76, s75, 10
    s_add_u32 s76, s76, s74
    buffer_load_dwordx4 v[128:131], v193, s[40:43], s76 offen
    s_lshr_b32 s76, s75, 1
    s_lshl_b32 s76, s76, 9
    s_and_b32 s77, s75, 1
    s_lshl_b32 s77, s77, 3
    s_add_u32 s76, s76, s77
    s_add_u32 s76, s76, s74
    buffer_load_dwordx2 v[136:137], v11, s[40:43], s76 offen
    s_mul_i32 s76, s75, 1344
    s_add_u32 s76, s76, s74
    buffer_load_dwordx4 v[144:147], v12, s[40:43], s76 offen
    buffer_load_dwordx4 v[148:151], v12, s[40:43], s76 offen offset:672
    s_waitcnt vmcnt(0)
    v_mfma_f32_32x32x4_2b_bf16 v[16:47], v[136:137], v[178:179], 0
    s_nop 15
    s_nop 3
    v_mfma_f32_32x32x16_bf16 v[16:31], v[128:131], v[168:171], v[16:31]
    v_mfma_f32_32x32x16_bf16 v[32:47], v[128:131], v[172:175], v[32:47]
    s_nop 15
    s_cmp_lg_u32 s72, 0
    s_cbranch_scc1 L_sl_p2
    v_max3_f32 v200, v200, v16, v17
    v_max3_f32 v200, v200, v18, v19
    v_max3_f32 v200, v200, v20, v21
    v_max3_f32 v200, v200, v22, v23
    v_max3_f32 v200, v200, v24, v25
    v_max3_f32 v200, v200, v26, v27
    v_max3_f32 v200, v200, v28, v29
    v_max3_f32 v200, v200, v30, v31
    v_max3_f32 v201, v201, v32, v33
    v_max3_f32 v201, v201, v34, v35
    v_max3_f32 v201, v201, v36, v37
    v_max3_f32 v201, v201, v38, v39
    v_max3_f32 v201, v201, v40, v41
    v_max3_f32 v201, v201, v42, v43
    v_max3_f32 v201, v201, v44, v45
    v_max3_f32 v201, v201, v46, v47
    s_branch L_sl_next
L_sl_p2:
    v_sub_f32 v16, v16, v200
    v_sub_f32 v17, v17, v200
    v_sub_f32 v18, v18, v200
    v_sub_f32 v19, v19, v200
    v_sub_f32 v20, v20, v200
    v_sub_f32 v21, v21, v200
    v_sub_f32 v22, v22, v200
    v_sub_f32 v23, v23, v200
    v_sub_f32 v24, v24, v200
    v_sub_f32 v25, v25, v200
    v_sub_f32 v26, v26, v200
    v_sub_f32 v27, v27, v200
    v_sub_f32 v28, v28, v200
    v_sub_f32 v29, v29, v200
    v_sub_f32 v30, v30, v200
    v_sub_f32 v31, v31, v200
    v_sub_f32 v32, v32, v201
    v_sub_f32 v33, v33, v201
    v_sub_f32 v34, v34, v201
    v_sub_f32 v35, v35, v201
    v_sub_f32 v36, v36, v201
    v_sub_f32 v37, v37, v201
    v_sub_f32 v38, v38, v201
    v_sub_f32 v39, v39, v201
    v_sub_f32 v40, v40, v201
    v_sub_f32 v41, v41, v201
    v_sub_f32 v42, v42, v201
    v_sub_f32 v43, v43, v201
    v_sub_f32 v44, v44, v201
    v_sub_f32 v45, v45, v201
    v_sub_f32 v46, v46, v201
    v_sub_f32 v47, v47, v201
    v_exp_f32 v16, v16
    v_exp_f32 v17, v17
    v_exp_f32 v18, v18
    v_exp_f32 v19, v19
    v_exp_f32 v20, v20
    v_exp_f32 v21, v21
    v_exp_f32 v22, v22
    v_exp_f32 v23, v23
    v_exp_f32 v24, v24
    v_exp_f32 v25, v25
    v_exp_f32 v26, v26
    v_exp_f32 v27, v27
    v_exp_f32 v28, v28
    v_exp_f32 v29, v29
    v_exp_f32 v30, v30
    v_exp_f32 v31, v31
    v_exp_f32 v32, v32
    v_exp_f32 v33, v33
    v_exp_f32 v34, v34
    v_exp_f32 v35, v35
    v_exp_f32 v36, v36
    v_exp_f32 v37, v37
    v_exp_f32 v38, v38
    v_exp_f32 v39, v39
    v_exp_f32 v40, v40
    v_exp_f32 v41, v41
    v_exp_f32 v42, v42
    v_exp_f32 v43, v43
    v_exp_f32 v44, v44
    v_exp_f32 v45, v45
    v_exp_f32 v46, v46
    v_exp_f32 v47, v47
    s_nop 0
    v_cvt_pk_bf16_f32 v112, v16, v17
    v_cvt_pk_bf16_f32 v113, v18, v19
    v_cvt_pk_bf16_f32 v114, v20, v21
    v_cvt_pk_bf16_f32 v115, v22, v23
    v_cvt_pk_bf16_f32 v116, v24, v25
    v_cvt_pk_bf16_f32 v117, v26, v27
    v_cvt_pk_bf16_f32 v118, v28, v29
    v_cvt_pk_bf16_f32 v119, v30, v31
    v_cvt_pk_bf16_f32 v120, v32, v33
    v_cvt_pk_bf16_f32 v121, v34, v35
    v_cvt_pk_bf16_f32 v122, v36, v37
    v_cvt_pk_bf16_f32 v123, v38, v39
    v_cvt_pk_bf16_f32 v124, v40, v41
    v_cvt_pk_bf16_f32 v125, v42, v43
    v_cvt_pk_bf16_f32 v126, v44, v45
    v_cvt_pk_bf16_f32 v127, v46, v47
    s_nop 1
    v_mfma_f32_32x32x16_bf16 v[80:95], v[144:147], v[112:115], v[80:95]
    v_mfma_f32_32x32x16_bf16 v[96:111], v[144:147], v[120:123], v[96:111]
    v_mfma_f32_32x32x16_bf16 v[80:95], v[148:151], v[116:119], v[80:95]
    v_mfma_f32_32x32x16_bf16 v[96:111], v[148:151], v[124:127], v[96:111]
    s_nop 15
L_sl_next:
    s_add_u32 s73, s73, 1
    s_cmp_lt_u32 s73, 64
    s_cbranch_scc1 L_sl_tile
    s_cmp_lg_u32 s72, 0
    s_cbranch_scc1 L_slow_ret
    v_mov_b32 v202, v200
    s_nop 1
    v_permlane32_swap_b32 v200, v202
    v_max_f32 v200, v200, v202
    v_mov_b32 v202, v201
    s_nop 1
    v_permlane32_swap_b32 v201, v202
    v_max_f32 v201, v201, v202
    s_mov_b32 s72, 1
    s_branch L_sl_pass
L_fin:
    s_or_b32 s61, s2, s52
    s_cmp_lg_u32 s61, 0
    s_cbranch_scc1 L_noep
    s_mov_b32 s61, 0
    s_mov_b64 exec, 1
    buffer_atomic_swap v243, off, s[40:43], s61 sc1
    s_mov_b64 exec, -1
L_noep:
L_exit:
    s_endpgm
.section .rodata,"a"
.p2align 6
.amdhsa_kernel interleave_layers__mha_block__mixer_token_mlp__prompt_kernel
  .amdhsa_next_free_vgpr 512
  .amdhsa_next_free_sgpr 102
  .amdhsa_accum_offset 256
  .amdhsa_group_segment_fixed_size 0
  .amdhsa_kernarg_size 88
  .amdhsa_user_sgpr_count 2
  .amdhsa_user_sgpr_kernarg_segment_ptr 1
  .amdhsa_system_sgpr_workgroup_id_x 1
.end_amdhsa_kernel
```
